```python
import torch

def _softmax(x, axis=-1):
    return torch.softmax(x, dim=axis)

def _gelu(x):
    return torch.nn.functional.gelu(x, approximate='tanh')

def _silu(x):
    return torch.nn.functional.silu(x)

def _sigmoid(x):
    return torch.sigmoid(x)

def _layernorm(x, axis=-1, eps=1e-05):
    m = x.mean(dim=axis, keepdim=True)
    v = x.var(dim=axis, keepdim=True, unbiased=False)
    return (x - m) / torch.sqrt(v + eps)

def _scatter_add(tgt, idx, src, axis=0):
    return tgt.clone().index_add_(axis, idx, src)

def _segment_sum(src, seg, n):
    out = torch.zeros((n,) + src.shape[1:], dtype=src.dtype)
    return out.index_add_(0, seg, src)

def _pad(x, pw):
    flat = tuple((v for pair in reversed(pw) for v in pair))
    return torch.nn.functional.pad(x, flat)
kernel_name = 'adaLN_cond__ssm_conv_s4__glu_gated_swiglu__prompt'

def setup_inputs():

    _w = lambda a: (lambda t: t.to(torch.bfloat16) if t.is_floating_point() else t)(torch.as_tensor(a))

    def _A_setup():
        B, L, D, N = (1, 2048, 640, 128)
        A_re = -(lambda _x: torch.exp(torch.as_tensor(_x)))((lambda *s: torch.randn(*s, dtype=torch.bfloat16) * 3.2)(D, N))
        A_im = torch.pi * (lambda *s: torch.randn(*s, dtype=torch.bfloat16) * 0.05)(D, N)
        B_re = (lambda *s: torch.randn(*s, dtype=torch.bfloat16) * 0.1)(D, N)
        B_im = (lambda *s: torch.randn(*s, dtype=torch.bfloat16) * 0.1)(D, N)
        C_re = (lambda *s: torch.randn(*s, dtype=torch.bfloat16) * 0.1)(D, N)
        C_im = (lambda *s: torch.randn(*s, dtype=torch.bfloat16) * 0.1)(D, N)
        log_dt = (lambda *s: torch.randn(*s, dtype=torch.bfloat16) * 0.05)(D) * 0.5 - 4.0
        Dskip = (lambda *s: torch.randn(*s, dtype=torch.bfloat16) * 0.05)(D)
        return {'u': _w((lambda *s: torch.randn(*s, dtype=torch.bfloat16) * 0.05)(B, L, D)), 'A_re': _w(A_re), 'A_im': _w(A_im), 'B_re': _w(B_re), 'B_im': _w(B_im), 'C_re': _w(C_re), 'C_im': _w(C_im), 'log_dt': _w(log_dt), 'Dskip': _w(Dskip)}
    _A_in = _A_setup()

    def _B_setup():
        B, S, D, F = (1, 2048, 640, 1728)
        return {'x': _w((lambda *s: torch.randn(*s, dtype=torch.bfloat16) * 0.05)(B, S, D)), 'w1': _w((lambda *s: torch.randn(*s, dtype=torch.bfloat16) * 0.4)(D, F) * (2.0 / D) ** 0.5), 'w3': _w((lambda *s: torch.randn(*s, dtype=torch.bfloat16) * 0.4)(D, F) * (2.0 / D) ** 0.5), 'w2': _w((lambda *s: torch.randn(*s, dtype=torch.bfloat16) * 0.4)(F, D) * (2.0 / F) ** 0.5)}
    _B_in = _B_setup()
    return {'A_u': _A_in['u'], 'A_A_re': _A_in['A_re'], 'A_A_im': _A_in['A_im'], 'A_B_re': _A_in['B_re'], 'A_B_im': _A_in['B_im'], 'A_C_re': _A_in['C_re'], 'A_C_im': _A_in['C_im'], 'A_log_dt': _A_in['log_dt'], 'A_Dskip': _A_in['Dskip'], 'B_x': _B_in['x'], 'B_w1': _B_in['w1'], 'B_w3': _B_in['w3'], 'B_w2': _B_in['w2'], 'c': _w((lambda *s: torch.randn(*s, dtype=torch.bfloat16) * 0.2)(1, 640) * 8.0), 'w_mod': _w((lambda *s: torch.randn(*s, dtype=torch.bfloat16) * 0.2)(640, 6 * 640) * 640 ** (-0.5) * 8.0)}

def reference(A_u, A_A_re, A_A_im, A_B_re, A_B_im, A_C_re, A_C_im, A_log_dt, A_Dskip, B_x, B_w1, B_w3, B_w2, c, w_mod):

    def _A_ref(u, A_re, A_im, B_re, B_im, C_re, C_im, log_dt, Dskip):
        Bsz, L, D = u.shape
        dt = torch.exp(log_dt)[:, None]
        A = A_re + 1j * A_im
        Bc = B_re + 1j * B_im
        Cc = C_re + 1j * C_im
        logdA = dt * A
        dB = dt * Bc
        l = (lambda x, dt: x.to(dt))(torch.arange(L), A_re.dtype)
        P = torch.exp(logdA[:, :, None] * l[None, None, :])
        K = torch.einsum('dn,dnl,dn->dl', Cc, P, dB).real
        L2 = 2 * L
        Kp = _pad(K, ((0, 0), (0, L)))
        up = (lambda x, *d: x.permute(*d))(u, 0, 2, 1)
        up = _pad(up, ((0, 0), (0, 0), (0, L)))
        Kf = (lambda x, axes=(-2, -1): torch.fft.rfft2(x.float(), dim=axes))(Kp[:, None, :], axes=(-2, -1))
        Uf = (lambda x, axes=(-2, -1): torch.fft.rfft2(x.float(), dim=axes))(up[:, :, None, :], axes=(-2, -1))
        Yf = Uf * Kf[None, :, :, :]
        y = (lambda x, s, axes=(-2, -1): torch.fft.irfft2(x, s=s, dim=axes).to(torch.bfloat16))(Yf, (1, L2), axes=(-2, -1))[:, :, 0, :L]
        y = (lambda x, *d: x.permute(*d))(y, 0, 2, 1) + u * Dskip[None, None, :]
        return y

    def _B_ref(x, w1, w3, w2):
        gate = torch.einsum('bsd,df->bsf', x, w1)
        up = torch.einsum('bsd,df->bsf', x, w3)
        h = _silu(gate) * up
        out = torch.einsum('bsf,fd->bsd', h, w2)
        return out
    x = A_u
    mod = (_silu(c) @ w_mod).reshape(c.shape[0], 6, 1, -1)
    sa, ca, ga, sb, cb, gb = (mod[:, 0].clone(), mod[:, 1].clone(), mod[:, 2].clone(), mod[:, 3].clone(), mod[:, 4].clone(), mod[:, 5].clone())
    h = _layernorm(x, axis=-1) * (1 + ca) + sa
    x = x + ga * _A_ref(h, A_A_re, A_A_im, A_B_re, A_B_im, A_C_re, A_C_im, A_log_dt, A_Dskip)
    h = _layernorm(x, axis=-1) * (1 + cb) + sb
    x = x + gb * _B_ref(h, B_w1, B_w3, B_w2)
    return x
```

```asm
; @launch kernel=k0_kernel grid=(1016,1,1) block=(256,1,1) lds=51712
; @launch kernel=k2_kernel grid=(640,1,1) block=(192,1,1) lds=43520
; @launch kernel=k3_kernel grid=(512,1,1) block=(256,1,1) lds=51200
; @launch kernel=k4_kernel grid=(432,1,1) block=(256,1,1) lds=75776
; @launch kernel=k5_kernel grid=(320,1,1) block=(256,1,1) lds=62464
.amdgcn_target "amdgcn-amd-amdhsa--gfx950"
.text
.globl k0_kernel
.p2align 8
.type k0_kernel,@function
k0_kernel:
    s_cmp_lt_u32 s2, 1016
    s_cbranch_scc1 K0_IN
    s_endpgm
K0_IN:
    s_add_u32 s3, s2, 376
    s_sub_u32 s4, s2, 640
    s_cmp_lt_u32 s2, 640
    s_cselect_b32 s2, s3, s4
    s_cmp_lt_u32 s2, 120
    s_cbranch_scc1 K0_MOD
    s_cmp_lt_u32 s2, 376
    s_cbranch_scc1 K0_ST
    s_cmp_lt_u32 s2, 1016
    s_cbranch_scc1 K0_KG
    s_endpgm
K0_MOD:
    s_load_dwordx2 s[4:5], s[0:1], 104
    s_load_dwordx2 s[6:7], s[0:1], 112
    s_load_dwordx2 s[8:9], s[0:1], 136
    s_waitcnt lgkmcnt(0)
    s_mov_b32 s12, s4
    s_and_b32 s13, s5, 0xffff
    s_mov_b32 s14, 1280
    s_mov_b32 s15, 0x20000
    s_mov_b32 s16, s6
    s_and_b32 s17, s7, 0xffff
    s_mov_b32 s18, 4915200
    s_mov_b32 s19, 0x20000
    s_mov_b32 s20, s8
    s_and_b32 s21, s9, 0xffff
    s_mov_b32 s22, 268435456
    s_mov_b32 s23, 0x20000
    v_lshlrev_b32 v1, 1, v0
    buffer_load_ushort v2, v1, s[12:15], 0 offen offset:0
    buffer_load_ushort v3, v1, s[12:15], 0 offen offset:512
    buffer_load_ushort v4, v1, s[12:15], 0 offen offset:1024
    s_mov_b32 s24, 0xbfb8aa3b
    v_lshlrev_b32 v8, 2, v0
    s_waitcnt vmcnt(0)
    v_lshlrev_b32 v2, 16, v2
    v_mul_f32 v5, s24, v2
    v_exp_f32 v5, v5
    s_nop 0
    v_add_f32 v5, 1.0, v5
    v_rcp_f32 v5, v5
    s_nop 0
    v_mul_f32 v5, v5, v2
    v_cvt_pk_bf16_f32 v5, v5, v5
    v_lshlrev_b32 v5, 16, v5
    ds_write_b32 v8, v5 offset:0
    v_lshlrev_b32 v3, 16, v3
    v_mul_f32 v5, s24, v3
    v_exp_f32 v5, v5
    s_nop 0
    v_add_f32 v5, 1.0, v5
    v_rcp_f32 v5, v5
    s_nop 0
    v_mul_f32 v5, v5, v3
    v_cvt_pk_bf16_f32 v5, v5, v5
    v_lshlrev_b32 v5, 16, v5
    ds_write_b32 v8, v5 offset:1024
    v_lshlrev_b32 v4, 16, v4
    v_mul_f32 v5, s24, v4
    v_exp_f32 v5, v5
    s_nop 0
    v_add_f32 v5, 1.0, v5
    v_rcp_f32 v5, v5
    s_nop 0
    v_mul_f32 v5, v5, v4
    v_cvt_pk_bf16_f32 v5, v5, v5
    v_lshlrev_b32 v5, 16, v5
    ds_write_b32 v8, v5 offset:2048
    v_and_b32 v6, 15, v0
    v_lshrrev_b32 v7, 4, v0
    s_mov_b32 s25, 7680
    v_mul_lo_u32 v9, v7, s25
    s_lshl_b32 s26, s2, 6
    v_lshl_add_u32 v9, v6, 2, v9
    v_add_u32 v9, s26, v9
    s_mov_b32 s27, 122880
    buffer_load_dword v16, v9, s[16:19], 0 offen
    v_add_u32 v9, s27, v9
    buffer_load_dword v17, v9, s[16:19], 0 offen
    v_add_u32 v9, s27, v9
    buffer_load_dword v18, v9, s[16:19], 0 offen
    v_add_u32 v9, s27, v9
    buffer_load_dword v19, v9, s[16:19], 0 offen
    v_add_u32 v9, s27, v9
    buffer_load_dword v20, v9, s[16:19], 0 offen
    v_add_u32 v9, s27, v9
    buffer_load_dword v21, v9, s[16:19], 0 offen
    v_add_u32 v9, s27, v9
    buffer_load_dword v22, v9, s[16:19], 0 offen
    v_add_u32 v9, s27, v9
    buffer_load_dword v23, v9, s[16:19], 0 offen
    v_add_u32 v9, s27, v9
    buffer_load_dword v24, v9, s[16:19], 0 offen
    v_add_u32 v9, s27, v9
    buffer_load_dword v25, v9, s[16:19], 0 offen
    v_add_u32 v9, s27, v9
    buffer_load_dword v26, v9, s[16:19], 0 offen
    v_add_u32 v9, s27, v9
    buffer_load_dword v27, v9, s[16:19], 0 offen
    v_add_u32 v9, s27, v9
    buffer_load_dword v28, v9, s[16:19], 0 offen
    v_add_u32 v9, s27, v9
    buffer_load_dword v29, v9, s[16:19], 0 offen
    v_add_u32 v9, s27, v9
    buffer_load_dword v30, v9, s[16:19], 0 offen
    v_add_u32 v9, s27, v9
    buffer_load_dword v31, v9, s[16:19], 0 offen
    v_add_u32 v9, s27, v9
    buffer_load_dword v32, v9, s[16:19], 0 offen
    v_add_u32 v9, s27, v9
    buffer_load_dword v33, v9, s[16:19], 0 offen
    v_add_u32 v9, s27, v9
    buffer_load_dword v34, v9, s[16:19], 0 offen
    v_add_u32 v9, s27, v9
    buffer_load_dword v35, v9, s[16:19], 0 offen
    v_add_u32 v9, s27, v9
    buffer_load_dword v36, v9, s[16:19], 0 offen
    v_add_u32 v9, s27, v9
    buffer_load_dword v37, v9, s[16:19], 0 offen
    v_add_u32 v9, s27, v9
    buffer_load_dword v38, v9, s[16:19], 0 offen
    v_add_u32 v9, s27, v9
    buffer_load_dword v39, v9, s[16:19], 0 offen
    v_add_u32 v9, s27, v9
    buffer_load_dword v40, v9, s[16:19], 0 offen
    v_add_u32 v9, s27, v9
    buffer_load_dword v41, v9, s[16:19], 0 offen
    v_add_u32 v9, s27, v9
    buffer_load_dword v42, v9, s[16:19], 0 offen
    v_add_u32 v9, s27, v9
    buffer_load_dword v43, v9, s[16:19], 0 offen
    v_add_u32 v9, s27, v9
    buffer_load_dword v44, v9, s[16:19], 0 offen
    v_add_u32 v9, s27, v9
    buffer_load_dword v45, v9, s[16:19], 0 offen
    v_add_u32 v9, s27, v9
    buffer_load_dword v46, v9, s[16:19], 0 offen
    v_add_u32 v9, s27, v9
    buffer_load_dword v47, v9, s[16:19], 0 offen
    v_add_u32 v9, s27, v9
    buffer_load_dword v48, v9, s[16:19], 0 offen
    v_add_u32 v9, s27, v9
    buffer_load_dword v49, v9, s[16:19], 0 offen
    v_add_u32 v9, s27, v9
    buffer_load_dword v50, v9, s[16:19], 0 offen
    v_add_u32 v9, s27, v9
    buffer_load_dword v51, v9, s[16:19], 0 offen
    v_add_u32 v9, s27, v9
    buffer_load_dword v52, v9, s[16:19], 0 offen
    v_add_u32 v9, s27, v9
    buffer_load_dword v53, v9, s[16:19], 0 offen
    v_add_u32 v9, s27, v9
    buffer_load_dword v54, v9, s[16:19], 0 offen
    v_add_u32 v9, s27, v9
    buffer_load_dword v55, v9, s[16:19], 0 offen
    s_waitcnt lgkmcnt(0)
    s_barrier
    v_lshlrev_b32 v10, 2, v7
    ds_read_b32 v60, v10 offset:0
    ds_read_b32 v61, v10 offset:64
    ds_read_b32 v62, v10 offset:128
    ds_read_b32 v63, v10 offset:192
    ds_read_b32 v64, v10 offset:256
    ds_read_b32 v65, v10 offset:320
    ds_read_b32 v66, v10 offset:384
    ds_read_b32 v67, v10 offset:448
    ds_read_b32 v68, v10 offset:512
    ds_read_b32 v69, v10 offset:576
    ds_read_b32 v70, v10 offset:640
    ds_read_b32 v71, v10 offset:704
    ds_read_b32 v72, v10 offset:768
    ds_read_b32 v73, v10 offset:832
    ds_read_b32 v74, v10 offset:896
    ds_read_b32 v75, v10 offset:960
    ds_read_b32 v76, v10 offset:1024
    ds_read_b32 v77, v10 offset:1088
    ds_read_b32 v78, v10 offset:1152
    ds_read_b32 v79, v10 offset:1216
    ds_read_b32 v80, v10 offset:1280
    ds_read_b32 v81, v10 offset:1344
    ds_read_b32 v82, v10 offset:1408
    ds_read_b32 v83, v10 offset:1472
    ds_read_b32 v84, v10 offset:1536
    ds_read_b32 v85, v10 offset:1600
    ds_read_b32 v86, v10 offset:1664
    ds_read_b32 v87, v10 offset:1728
    ds_read_b32 v88, v10 offset:1792
    ds_read_b32 v89, v10 offset:1856
    ds_read_b32 v90, v10 offset:1920
    ds_read_b32 v91, v10 offset:1984
    ds_read_b32 v92, v10 offset:2048
    ds_read_b32 v93, v10 offset:2112
    ds_read_b32 v94, v10 offset:2176
    ds_read_b32 v95, v10 offset:2240
    ds_read_b32 v96, v10 offset:2304
    ds_read_b32 v97, v10 offset:2368
    ds_read_b32 v98, v10 offset:2432
    ds_read_b32 v99, v10 offset:2496
    v_mov_b32 v12, 0
    v_mov_b32 v13, 0
    s_waitcnt vmcnt(0) lgkmcnt(0)
    v_lshlrev_b32 v14, 16, v16
    v_and_b32 v15, 0xffff0000, v16
    v_fmac_f32 v12, v60, v14
    v_fmac_f32 v13, v60, v15
    v_lshlrev_b32 v14, 16, v17
    v_and_b32 v15, 0xffff0000, v17
    v_fmac_f32 v12, v61, v14
    v_fmac_f32 v13, v61, v15
    v_lshlrev_b32 v14, 16, v18
    v_and_b32 v15, 0xffff0000, v18
    v_fmac_f32 v12, v62, v14
    v_fmac_f32 v13, v62, v15
    v_lshlrev_b32 v14, 16, v19
    v_and_b32 v15, 0xffff0000, v19
    v_fmac_f32 v12, v63, v14
    v_fmac_f32 v13, v63, v15
    v_lshlrev_b32 v14, 16, v20
    v_and_b32 v15, 0xffff0000, v20
    v_fmac_f32 v12, v64, v14
    v_fmac_f32 v13, v64, v15
    v_lshlrev_b32 v14, 16, v21
    v_and_b32 v15, 0xffff0000, v21
    v_fmac_f32 v12, v65, v14
    v_fmac_f32 v13, v65, v15
    v_lshlrev_b32 v14, 16, v22
    v_and_b32 v15, 0xffff0000, v22
    v_fmac_f32 v12, v66, v14
    v_fmac_f32 v13, v66, v15
    v_lshlrev_b32 v14, 16, v23
    v_and_b32 v15, 0xffff0000, v23
    v_fmac_f32 v12, v67, v14
    v_fmac_f32 v13, v67, v15
    v_lshlrev_b32 v14, 16, v24
    v_and_b32 v15, 0xffff0000, v24
    v_fmac_f32 v12, v68, v14
    v_fmac_f32 v13, v68, v15
    v_lshlrev_b32 v14, 16, v25
    v_and_b32 v15, 0xffff0000, v25
    v_fmac_f32 v12, v69, v14
    v_fmac_f32 v13, v69, v15
    v_lshlrev_b32 v14, 16, v26
    v_and_b32 v15, 0xffff0000, v26
    v_fmac_f32 v12, v70, v14
    v_fmac_f32 v13, v70, v15
    v_lshlrev_b32 v14, 16, v27
    v_and_b32 v15, 0xffff0000, v27
    v_fmac_f32 v12, v71, v14
    v_fmac_f32 v13, v71, v15
    v_lshlrev_b32 v14, 16, v28
    v_and_b32 v15, 0xffff0000, v28
    v_fmac_f32 v12, v72, v14
    v_fmac_f32 v13, v72, v15
    v_lshlrev_b32 v14, 16, v29
    v_and_b32 v15, 0xffff0000, v29
    v_fmac_f32 v12, v73, v14
    v_fmac_f32 v13, v73, v15
    v_lshlrev_b32 v14, 16, v30
    v_and_b32 v15, 0xffff0000, v30
    v_fmac_f32 v12, v74, v14
    v_fmac_f32 v13, v74, v15
    v_lshlrev_b32 v14, 16, v31
    v_and_b32 v15, 0xffff0000, v31
    v_fmac_f32 v12, v75, v14
    v_fmac_f32 v13, v75, v15
    v_lshlrev_b32 v14, 16, v32
    v_and_b32 v15, 0xffff0000, v32
    v_fmac_f32 v12, v76, v14
    v_fmac_f32 v13, v76, v15
    v_lshlrev_b32 v14, 16, v33
    v_and_b32 v15, 0xffff0000, v33
    v_fmac_f32 v12, v77, v14
    v_fmac_f32 v13, v77, v15
    v_lshlrev_b32 v14, 16, v34
    v_and_b32 v15, 0xffff0000, v34
    v_fmac_f32 v12, v78, v14
    v_fmac_f32 v13, v78, v15
    v_lshlrev_b32 v14, 16, v35
    v_and_b32 v15, 0xffff0000, v35
    v_fmac_f32 v12, v79, v14
    v_fmac_f32 v13, v79, v15
    v_lshlrev_b32 v14, 16, v36
    v_and_b32 v15, 0xffff0000, v36
    v_fmac_f32 v12, v80, v14
    v_fmac_f32 v13, v80, v15
    v_lshlrev_b32 v14, 16, v37
    v_and_b32 v15, 0xffff0000, v37
    v_fmac_f32 v12, v81, v14
    v_fmac_f32 v13, v81, v15
    v_lshlrev_b32 v14, 16, v38
    v_and_b32 v15, 0xffff0000, v38
    v_fmac_f32 v12, v82, v14
    v_fmac_f32 v13, v82, v15
    v_lshlrev_b32 v14, 16, v39
    v_and_b32 v15, 0xffff0000, v39
    v_fmac_f32 v12, v83, v14
    v_fmac_f32 v13, v83, v15
    v_lshlrev_b32 v14, 16, v40
    v_and_b32 v15, 0xffff0000, v40
    v_fmac_f32 v12, v84, v14
    v_fmac_f32 v13, v84, v15
    v_lshlrev_b32 v14, 16, v41
    v_and_b32 v15, 0xffff0000, v41
    v_fmac_f32 v12, v85, v14
    v_fmac_f32 v13, v85, v15
    v_lshlrev_b32 v14, 16, v42
    v_and_b32 v15, 0xffff0000, v42
    v_fmac_f32 v12, v86, v14
    v_fmac_f32 v13, v86, v15
    v_lshlrev_b32 v14, 16, v43
    v_and_b32 v15, 0xffff0000, v43
    v_fmac_f32 v12, v87, v14
    v_fmac_f32 v13, v87, v15
    v_lshlrev_b32 v14, 16, v44
    v_and_b32 v15, 0xffff0000, v44
    v_fmac_f32 v12, v88, v14
    v_fmac_f32 v13, v88, v15
    v_lshlrev_b32 v14, 16, v45
    v_and_b32 v15, 0xffff0000, v45
    v_fmac_f32 v12, v89, v14
    v_fmac_f32 v13, v89, v15
    v_lshlrev_b32 v14, 16, v46
    v_and_b32 v15, 0xffff0000, v46
    v_fmac_f32 v12, v90, v14
    v_fmac_f32 v13, v90, v15
    v_lshlrev_b32 v14, 16, v47
    v_and_b32 v15, 0xffff0000, v47
    v_fmac_f32 v12, v91, v14
    v_fmac_f32 v13, v91, v15
    v_lshlrev_b32 v14, 16, v48
    v_and_b32 v15, 0xffff0000, v48
    v_fmac_f32 v12, v92, v14
    v_fmac_f32 v13, v92, v15
    v_lshlrev_b32 v14, 16, v49
    v_and_b32 v15, 0xffff0000, v49
    v_fmac_f32 v12, v93, v14
    v_fmac_f32 v13, v93, v15
    v_lshlrev_b32 v14, 16, v50
    v_and_b32 v15, 0xffff0000, v50
    v_fmac_f32 v12, v94, v14
    v_fmac_f32 v13, v94, v15
    v_lshlrev_b32 v14, 16, v51
    v_and_b32 v15, 0xffff0000, v51
    v_fmac_f32 v12, v95, v14
    v_fmac_f32 v13, v95, v15
    v_lshlrev_b32 v14, 16, v52
    v_and_b32 v15, 0xffff0000, v52
    v_fmac_f32 v12, v96, v14
    v_fmac_f32 v13, v96, v15
    v_lshlrev_b32 v14, 16, v53
    v_and_b32 v15, 0xffff0000, v53
    v_fmac_f32 v12, v97, v14
    v_fmac_f32 v13, v97, v15
    v_lshlrev_b32 v14, 16, v54
    v_and_b32 v15, 0xffff0000, v54
    v_fmac_f32 v12, v98, v14
    v_fmac_f32 v13, v98, v15
    v_lshlrev_b32 v14, 16, v55
    v_and_b32 v15, 0xffff0000, v55
    v_fmac_f32 v12, v99, v14
    v_fmac_f32 v13, v99, v15
    v_lshlrev_b32 v10, 7, v7
    v_lshl_add_u32 v10, v6, 3, v10
    ds_write_b64 v10, v[12:13] offset:4096
    s_waitcnt lgkmcnt(0)
    s_barrier
    v_cmp_gt_u32 vcc, 32, v0
    s_and_saveexec_b64 s[28:29], vcc
    s_cbranch_execz K0_MOD_END
    v_lshlrev_b32 v10, 2, v0
    ds_read_b32 v16, v10 offset:4096
    ds_read_b32 v17, v10 offset:4224
    ds_read_b32 v18, v10 offset:4352
    ds_read_b32 v19, v10 offset:4480
    ds_read_b32 v20, v10 offset:4608
    ds_read_b32 v21, v10 offset:4736
    ds_read_b32 v22, v10 offset:4864
    ds_read_b32 v23, v10 offset:4992
    ds_read_b32 v24, v10 offset:5120
    ds_read_b32 v25, v10 offset:5248
    ds_read_b32 v26, v10 offset:5376
    ds_read_b32 v27, v10 offset:5504
    ds_read_b32 v28, v10 offset:5632
    ds_read_b32 v29, v10 offset:5760
    ds_read_b32 v30, v10 offset:5888
    ds_read_b32 v31, v10 offset:6016
    s_waitcnt lgkmcnt(0)
    v_add_f32 v16, v16, v17
    v_add_f32 v16, v16, v18
    v_add_f32 v16, v16, v19
    v_add_f32 v16, v16, v20
    v_add_f32 v16, v16, v21
    v_add_f32 v16, v16, v22
    v_add_f32 v16, v16, v23
    v_add_f32 v16, v16, v24
    v_add_f32 v16, v16, v25
    v_add_f32 v16, v16, v26
    v_add_f32 v16, v16, v27
    v_add_f32 v16, v16, v28
    v_add_f32 v16, v16, v29
    v_add_f32 v16, v16, v30
    v_add_f32 v16, v16, v31
    v_cvt_pk_bf16_f32 v16, v16, v16
    v_lshlrev_b32 v16, 16, v16
    s_lshl_b32 s26, s2, 7
    v_add_u32 v10, s26, v10
    buffer_store_dword v16, v10, s[20:23], 0 offen offset:0
K0_MOD_END:
    s_endpgm
K0_ST:
    s_load_dwordx2 s[4:5], s[0:1], 0
    s_load_dwordx2 s[8:9], s[0:1], 136
    s_waitcnt lgkmcnt(0)
    s_mov_b32 s12, s4
    s_and_b32 s13, s5, 0xffff
    s_mov_b32 s14, 2621440
    s_mov_b32 s15, 0x20000
    s_mov_b32 s20, s8
    s_and_b32 s21, s9, 0xffff
    s_mov_b32 s22, 268435456
    s_mov_b32 s23, 0x20000
    s_sub_u32 s3, s2, 120
    s_lshl_b32 s24, s3, 3
    v_and_b32 v1, 63, v0
    v_lshrrev_b32 v2, 6, v0
    v_lshl_add_u32 v3, v2, 1, s24
    s_movk_i32 s25, 1280
    v_mul_lo_u32 v3, v3, s25
    v_lshl_add_u32 v3, v1, 2, v3
    buffer_load_dword v16, v3, s[12:15], 0 offen offset:0
    buffer_load_dword v17, v3, s[12:15], 0 offen offset:256
    buffer_load_dword v18, v3, s[12:15], 0 offen offset:512
    buffer_load_dword v19, v3, s[12:15], 0 offen offset:768
    buffer_load_dword v20, v3, s[12:15], 0 offen offset:1024
    v_add_u32 v3, 1280, v3
    buffer_load_dword v21, v3, s[12:15], 0 offen offset:0
    buffer_load_dword v22, v3, s[12:15], 0 offen offset:256
    buffer_load_dword v23, v3, s[12:15], 0 offen offset:512
    buffer_load_dword v24, v3, s[12:15], 0 offen offset:768
    buffer_load_dword v25, v3, s[12:15], 0 offen offset:1024
    v_add_u32 v3, 1280, v3
    s_waitcnt vmcnt(0)
    s_mov_b32 s26, 0x3acccccd
    v_mov_b32 v5, 0
    v_lshlrev_b32 v6, 16, v16
    v_and_b32 v7, 0xffff0000, v16
    v_add_f32 v5, v5, v6
    v_add_f32 v5, v5, v7
    v_lshlrev_b32 v6, 16, v17
    v_and_b32 v7, 0xffff0000, v17
    v_add_f32 v5, v5, v6
    v_add_f32 v5, v5, v7
    v_lshlrev_b32 v6, 16, v18
    v_and_b32 v7, 0xffff0000, v18
    v_add_f32 v5, v5, v6
    v_add_f32 v5, v5, v7
    v_lshlrev_b32 v6, 16, v19
    v_and_b32 v7, 0xffff0000, v19
    v_add_f32 v5, v5, v6
    v_add_f32 v5, v5, v7
    v_lshlrev_b32 v6, 16, v20
    v_and_b32 v7, 0xffff0000, v20
    v_add_f32 v5, v5, v6
    v_add_f32 v5, v5, v7
    v_mov_b32 v8, 0
    s_nop 1
    v_mov_b32_dpp v8, v5 row_shr:1 row_mask:0xf bank_mask:0xf
    v_add_f32 v5, v5, v8
    s_nop 1
    v_mov_b32 v8, 0
    s_nop 1
    v_mov_b32_dpp v8, v5 row_shr:2 row_mask:0xf bank_mask:0xf
    v_add_f32 v5, v5, v8
    s_nop 1
    v_mov_b32 v8, 0
    s_nop 1
    v_mov_b32_dpp v8, v5 row_shr:4 row_mask:0xf bank_mask:0xf
    v_add_f32 v5, v5, v8
    s_nop 1
    v_mov_b32 v8, 0
    s_nop 1
    v_mov_b32_dpp v8, v5 row_shr:8 row_mask:0xf bank_mask:0xf
    v_add_f32 v5, v5, v8
    s_nop 1
    v_mov_b32 v8, 0
    s_nop 1
    v_mov_b32_dpp v8, v5 row_bcast:15 row_mask:0xa bank_mask:0xf
    v_add_f32 v5, v5, v8
    s_nop 1
    v_mov_b32 v8, 0
    s_nop 1
    v_mov_b32_dpp v8, v5 row_bcast:31 row_mask:0xc bank_mask:0xf
    v_add_f32 v5, v5, v8
    s_nop 1
    v_readlane_b32 s27, v5, 63
    s_nop 3
    v_mov_b32 v9, s27
    v_mul_f32 v9, s26, v9
    v_mov_b32 v5, 0
    v_lshlrev_b32 v6, 16, v16
    v_and_b32 v7, 0xffff0000, v16
    v_sub_f32 v6, v6, v9
    v_sub_f32 v7, v7, v9
    v_fmac_f32 v5, v6, v6
    v_fmac_f32 v5, v7, v7
    v_lshlrev_b32 v6, 16, v17
    v_and_b32 v7, 0xffff0000, v17
    v_sub_f32 v6, v6, v9
    v_sub_f32 v7, v7, v9
    v_fmac_f32 v5, v6, v6
    v_fmac_f32 v5, v7, v7
    v_lshlrev_b32 v6, 16, v18
    v_and_b32 v7, 0xffff0000, v18
    v_sub_f32 v6, v6, v9
    v_sub_f32 v7, v7, v9
    v_fmac_f32 v5, v6, v6
    v_fmac_f32 v5, v7, v7
    v_lshlrev_b32 v6, 16, v19
    v_and_b32 v7, 0xffff0000, v19
    v_sub_f32 v6, v6, v9
    v_sub_f32 v7, v7, v9
    v_fmac_f32 v5, v6, v6
    v_fmac_f32 v5, v7, v7
    v_lshlrev_b32 v6, 16, v20
    v_and_b32 v7, 0xffff0000, v20
    v_sub_f32 v6, v6, v9
    v_sub_f32 v7, v7, v9
    v_fmac_f32 v5, v6, v6
    v_fmac_f32 v5, v7, v7
    v_mov_b32 v8, 0
    s_nop 1
    v_mov_b32_dpp v8, v5 row_shr:1 row_mask:0xf bank_mask:0xf
    v_add_f32 v5, v5, v8
    s_nop 1
    v_mov_b32 v8, 0
    s_nop 1
    v_mov_b32_dpp v8, v5 row_shr:2 row_mask:0xf bank_mask:0xf
    v_add_f32 v5, v5, v8
    s_nop 1
    v_mov_b32 v8, 0
    s_nop 1
    v_mov_b32_dpp v8, v5 row_shr:4 row_mask:0xf bank_mask:0xf
    v_add_f32 v5, v5, v8
    s_nop 1
    v_mov_b32 v8, 0
    s_nop 1
    v_mov_b32_dpp v8, v5 row_shr:8 row_mask:0xf bank_mask:0xf
    v_add_f32 v5, v5, v8
    s_nop 1
    v_mov_b32 v8, 0
    s_nop 1
    v_mov_b32_dpp v8, v5 row_bcast:15 row_mask:0xa bank_mask:0xf
    v_add_f32 v5, v5, v8
    s_nop 1
    v_mov_b32 v8, 0
    s_nop 1
    v_mov_b32_dpp v8, v5 row_bcast:31 row_mask:0xc bank_mask:0xf
    v_add_f32 v5, v5, v8
    s_nop 1
    v_readlane_b32 s27, v5, 63
    s_nop 3
    v_mov_b32 v5, s27
    v_mul_f32 v5, s26, v5
    v_cvt_pk_bf16_f32 v5, v5, v5
    v_lshlrev_b32 v5, 16, v5
    v_add_f32 v5, 0x3727c5ac, v5
    v_cvt_pk_bf16_f32 v5, v5, v5
    v_lshlrev_b32 v5, 16, v5
    v_sqrt_f32 v5, v5
    s_nop 0
    v_cvt_pk_bf16_f32 v5, v5, v5
    v_lshlrev_b32 v5, 16, v5
    v_cvt_pk_bf16_f32 v9, v9, v9
    v_lshlrev_b32 v9, 16, v9
    v_lshl_add_u32 v10, v2, 1, s24
    v_add_u32 v10, 0, v10
    v_lshlrev_b32 v10, 2, v10
    v_cmp_eq_u32 vcc, 0, v1
    s_and_saveexec_b64 s[28:29], vcc
    s_mov_b32 s30, 16384
    buffer_store_dword v9, v10, s[20:23], s30 offen
    s_mov_b32 s30, 24576
    buffer_store_dword v5, v10, s[20:23], s30 offen
    s_mov_b64 exec, s[28:29]
    v_mov_b32 v5, 0
    v_lshlrev_b32 v6, 16, v21
    v_and_b32 v7, 0xffff0000, v21
    v_add_f32 v5, v5, v6
    v_add_f32 v5, v5, v7
    v_lshlrev_b32 v6, 16, v22
    v_and_b32 v7, 0xffff0000, v22
    v_add_f32 v5, v5, v6
    v_add_f32 v5, v5, v7
    v_lshlrev_b32 v6, 16, v23
    v_and_b32 v7, 0xffff0000, v23
    v_add_f32 v5, v5, v6
    v_add_f32 v5, v5, v7
    v_lshlrev_b32 v6, 16, v24
    v_and_b32 v7, 0xffff0000, v24
    v_add_f32 v5, v5, v6
    v_add_f32 v5, v5, v7
    v_lshlrev_b32 v6, 16, v25
    v_and_b32 v7, 0xffff0000, v25
    v_add_f32 v5, v5, v6
    v_add_f32 v5, v5, v7
    v_mov_b32 v8, 0
    s_nop 1
    v_mov_b32_dpp v8, v5 row_shr:1 row_mask:0xf bank_mask:0xf
    v_add_f32 v5, v5, v8
    s_nop 1
    v_mov_b32 v8, 0
    s_nop 1
    v_mov_b32_dpp v8, v5 row_shr:2 row_mask:0xf bank_mask:0xf
    v_add_f32 v5, v5, v8
    s_nop 1
    v_mov_b32 v8, 0
    s_nop 1
    v_mov_b32_dpp v8, v5 row_shr:4 row_mask:0xf bank_mask:0xf
    v_add_f32 v5, v5, v8
    s_nop 1
    v_mov_b32 v8, 0
    s_nop 1
    v_mov_b32_dpp v8, v5 row_shr:8 row_mask:0xf bank_mask:0xf
    v_add_f32 v5, v5, v8
    s_nop 1
    v_mov_b32 v8, 0
    s_nop 1
    v_mov_b32_dpp v8, v5 row_bcast:15 row_mask:0xa bank_mask:0xf
    v_add_f32 v5, v5, v8
    s_nop 1
    v_mov_b32 v8, 0
    s_nop 1
    v_mov_b32_dpp v8, v5 row_bcast:31 row_mask:0xc bank_mask:0xf
    v_add_f32 v5, v5, v8
    s_nop 1
    v_readlane_b32 s27, v5, 63
    s_nop 3
    v_mov_b32 v9, s27
    v_mul_f32 v9, s26, v9
    v_mov_b32 v5, 0
    v_lshlrev_b32 v6, 16, v21
    v_and_b32 v7, 0xffff0000, v21
    v_sub_f32 v6, v6, v9
    v_sub_f32 v7, v7, v9
    v_fmac_f32 v5, v6, v6
    v_fmac_f32 v5, v7, v7
    v_lshlrev_b32 v6, 16, v22
    v_and_b32 v7, 0xffff0000, v22
    v_sub_f32 v6, v6, v9
    v_sub_f32 v7, v7, v9
    v_fmac_f32 v5, v6, v6
    v_fmac_f32 v5, v7, v7
    v_lshlrev_b32 v6, 16, v23
    v_and_b32 v7, 0xffff0000, v23
    v_sub_f32 v6, v6, v9
    v_sub_f32 v7, v7, v9
    v_fmac_f32 v5, v6, v6
    v_fmac_f32 v5, v7, v7
    v_lshlrev_b32 v6, 16, v24
    v_and_b32 v7, 0xffff0000, v24
    v_sub_f32 v6, v6, v9
    v_sub_f32 v7, v7, v9
    v_fmac_f32 v5, v6, v6
    v_fmac_f32 v5, v7, v7
    v_lshlrev_b32 v6, 16, v25
    v_and_b32 v7, 0xffff0000, v25
    v_sub_f32 v6, v6, v9
    v_sub_f32 v7, v7, v9
    v_fmac_f32 v5, v6, v6
    v_fmac_f32 v5, v7, v7
    v_mov_b32 v8, 0
    s_nop 1
    v_mov_b32_dpp v8, v5 row_shr:1 row_mask:0xf bank_mask:0xf
    v_add_f32 v5, v5, v8
    s_nop 1
    v_mov_b32 v8, 0
    s_nop 1
    v_mov_b32_dpp v8, v5 row_shr:2 row_mask:0xf bank_mask:0xf
    v_add_f32 v5, v5, v8
    s_nop 1
    v_mov_b32 v8, 0
    s_nop 1
    v_mov_b32_dpp v8, v5 row_shr:4 row_mask:0xf bank_mask:0xf
    v_add_f32 v5, v5, v8
    s_nop 1
    v_mov_b32 v8, 0
    s_nop 1
    v_mov_b32_dpp v8, v5 row_shr:8 row_mask:0xf bank_mask:0xf
    v_add_f32 v5, v5, v8
    s_nop 1
    v_mov_b32 v8, 0
    s_nop 1
    v_mov_b32_dpp v8, v5 row_bcast:15 row_mask:0xa bank_mask:0xf
    v_add_f32 v5, v5, v8
    s_nop 1
    v_mov_b32 v8, 0
    s_nop 1
    v_mov_b32_dpp v8, v5 row_bcast:31 row_mask:0xc bank_mask:0xf
    v_add_f32 v5, v5, v8
    s_nop 1
    v_readlane_b32 s27, v5, 63
    s_nop 3
    v_mov_b32 v5, s27
    v_mul_f32 v5, s26, v5
    v_cvt_pk_bf16_f32 v5, v5, v5
    v_lshlrev_b32 v5, 16, v5
    v_add_f32 v5, 0x3727c5ac, v5
    v_cvt_pk_bf16_f32 v5, v5, v5
    v_lshlrev_b32 v5, 16, v5
    v_sqrt_f32 v5, v5
    s_nop 0
    v_cvt_pk_bf16_f32 v5, v5, v5
    v_lshlrev_b32 v5, 16, v5
    v_cvt_pk_bf16_f32 v9, v9, v9
    v_lshlrev_b32 v9, 16, v9
    v_lshl_add_u32 v10, v2, 1, s24
    v_add_u32 v10, 1, v10
    v_lshlrev_b32 v10, 2, v10
    v_cmp_eq_u32 vcc, 0, v1
    s_and_saveexec_b64 s[28:29], vcc
    s_mov_b32 s30, 16384
    buffer_store_dword v9, v10, s[20:23], s30 offen
    s_mov_b32 s30, 24576
    buffer_store_dword v5, v10, s[20:23], s30 offen
    s_mov_b64 exec, s[28:29]
    s_mov_b32 s33, 0xffff0000
    v_lshlrev_b32 v11, 2, v2
    s_movk_i32 s25, 160
    v_mul_lo_u32 v12, v1, s25
    v_add_u32 v11, v11, v12
    v_and_b32 v13, 0xffff, v16
    v_lshl_or_b32 v13, v21, 16, v13
    v_lshrrev_b32 v14, 16, v16
    v_and_or_b32 v14, v21, s33, v14
    ds_write_b32 v11, v13 offset:0
    ds_write_b32 v11, v14 offset:80
    v_and_b32 v13, 0xffff, v17
    v_lshl_or_b32 v13, v22, 16, v13
    v_lshrrev_b32 v14, 16, v17
    v_and_or_b32 v14, v22, s33, v14
    ds_write_b32 v11, v13 offset:10240
    ds_write_b32 v11, v14 offset:10320
    v_and_b32 v13, 0xffff, v18
    v_lshl_or_b32 v13, v23, 16, v13
    v_lshrrev_b32 v14, 16, v18
    v_and_or_b32 v14, v23, s33, v14
    ds_write_b32 v11, v13 offset:20480
    ds_write_b32 v11, v14 offset:20560
    v_and_b32 v13, 0xffff, v19
    v_lshl_or_b32 v13, v24, 16, v13
    v_lshrrev_b32 v14, 16, v19
    v_and_or_b32 v14, v24, s33, v14
    ds_write_b32 v11, v13 offset:30720
    ds_write_b32 v11, v14 offset:30800
    v_and_b32 v13, 0xffff, v20
    v_lshl_or_b32 v13, v25, 16, v13
    v_lshrrev_b32 v14, 16, v20
    v_and_or_b32 v14, v25, s33, v14
    ds_write_b32 v11, v13 offset:40960
    ds_write_b32 v11, v14 offset:41040
    s_waitcnt lgkmcnt(0)
    s_barrier
    s_movk_i32 s25, 80
    v_mul_lo_u32 v11, v0, s25
    s_movk_i32 s25, 4224
    v_mul_lo_u32 v12, v0, s25
    s_lshl_b32 s27, s24, 1
    s_add_u32 s27, s27, 65536
    v_add_u32 v12, s27, v12
    ds_read_b128 v[16:19], v11 offset:0
    s_waitcnt lgkmcnt(0)
    buffer_store_dwordx4 v[16:19], v12, s[20:23], 0 offen offset:0
    v_add_u32 v12, 0x108000, v12
    s_nop 1
    ds_read_b128 v[16:19], v11 offset:20480
    s_waitcnt lgkmcnt(0)
    buffer_store_dwordx4 v[16:19], v12, s[20:23], 0 offen offset:0
    v_add_u32 v12, 0x108000, v12
    s_nop 1
    v_cmp_gt_u32 vcc, 128, v0
    s_and_saveexec_b64 s[28:29], vcc
    s_cbranch_execz K0_ST_END
    ds_read_b128 v[16:19], v11 offset:40960
    s_waitcnt lgkmcnt(0)
    buffer_store_dwordx4 v[16:19], v12, s[20:23], 0 offen offset:0
    v_add_u32 v12, 0x108000, v12
    s_nop 1
K0_ST_END:
    s_endpgm
K0_KG:
    s_load_dwordx2 s[4:5], s[0:1], 8
    s_load_dwordx2 s[6:7], s[0:1], 16
    s_load_dwordx2 s[8:9], s[0:1], 24
    s_load_dwordx2 s[10:11], s[0:1], 32
    s_load_dwordx2 s[12:13], s[0:1], 40
    s_load_dwordx2 s[14:15], s[0:1], 48
    s_load_dwordx2 s[16:17], s[0:1], 56
    s_load_dwordx2 s[18:19], s[0:1], 136
    s_waitcnt lgkmcnt(0)
    s_mov_b32 s20, s18
    s_and_b32 s21, s19, 0xffff
    s_mov_b32 s22, 268435456
    s_mov_b32 s23, 0x20000
    s_mov_b32 s24, s16
    s_and_b32 s25, s17, 0xffff
    s_mov_b32 s26, 1280
    s_mov_b32 s27, 0x20000
    s_sub_u32 s3, s2, 376
    v_and_b32 v1, 127, v0
    v_lshrrev_b32 v2, 7, v0
    s_lshl_b32 s40, s3, 8
    v_lshl_add_u32 v3, v1, 1, s40
    s_mov_b32 s28, s4
    s_and_b32 s29, s5, 0xffff
    s_mov_b32 s30, 163840
    s_mov_b32 s31, 0x20000
    buffer_load_ushort v10, v3, s[28:31], 0 offen
    s_mov_b32 s28, s6
    s_and_b32 s29, s7, 0xffff
    s_mov_b32 s30, 163840
    s_mov_b32 s31, 0x20000
    buffer_load_ushort v11, v3, s[28:31], 0 offen
    s_mov_b32 s28, s8
    s_and_b32 s29, s9, 0xffff
    s_mov_b32 s30, 163840
    s_mov_b32 s31, 0x20000
    buffer_load_ushort v12, v3, s[28:31], 0 offen
    s_mov_b32 s28, s10
    s_and_b32 s29, s11, 0xffff
    s_mov_b32 s30, 163840
    s_mov_b32 s31, 0x20000
    buffer_load_ushort v13, v3, s[28:31], 0 offen
    s_mov_b32 s28, s12
    s_and_b32 s29, s13, 0xffff
    s_mov_b32 s30, 163840
    s_mov_b32 s31, 0x20000
    buffer_load_ushort v14, v3, s[28:31], 0 offen
    s_mov_b32 s28, s14
    s_and_b32 s29, s15, 0xffff
    s_mov_b32 s30, 163840
    s_mov_b32 s31, 0x20000
    buffer_load_ushort v15, v3, s[28:31], 0 offen
    s_lshl_b32 s41, s3, 1
    v_mov_b32 v4, s41
    buffer_load_ushort v16, v4, s[24:27], 0 offen
    s_waitcnt vmcnt(0)
    v_lshlrev_b32 v10, 16, v10
    v_lshlrev_b32 v11, 16, v11
    v_lshlrev_b32 v12, 16, v12
    v_lshlrev_b32 v13, 16, v13
    v_lshlrev_b32 v14, 16, v14
    v_lshlrev_b32 v15, 16, v15
    v_lshlrev_b32 v16, 16, v16
    s_mov_b32 s42, 0x3fb8aa3b
    s_mov_b32 s43, 0x3e22f983
    v_mul_f32 v16, s42, v16
    v_exp_f32 v16, v16
    s_nop 0
    v_cvt_pk_bf16_f32 v16, v16, v16
    v_lshlrev_b32 v16, 16, v16
    v_mul_f32 v10, v16, v10
    v_mul_f32 v11, v16, v11
    v_mul_f32 v12, v16, v12
    v_mul_f32 v13, v16, v13
    v_mul_f32 v10, s42, v10
    v_mul_f32 v11, s43, v11
    v_mul_f32 v17, v14, v12
    v_fma_f32 v17, -v15, v13, v17
    v_mul_f32 v18, v14, v13
    v_fma_f32 v18, v15, v12, v18
    v_cmp_eq_u32 vcc, 1, v2
    s_mov_b64 s[44:45], vcc
    s_movk_i32 s46, 136
    v_mul_lo_u32 v5, v1, s46
    s_movk_i32 s46, 17408
    v_mul_lo_u32 v8, v2, s46
    v_add_u32 v5, v5, v8
    v_and_b32 v6, 63, v0
    v_lshrrev_b32 v7, 6, v0
    v_lshlrev_b32 v9, 6, v7
    v_lshrrev_b32 v46, 4, v6
    v_add_u32 v9, v9, v46
    s_movk_i32 s46, 68
    v_mul_lo_u32 v9, v9, s46
    v_and_b32 v46, 15, v6
    v_lshl_add_u32 v9, v46, 2, v9
    v_lshlrev_b32 v56, 10, v7
    v_lshrrev_b32 v57, 4, v6
    v_lshl_add_u32 v56, v57, 8, v56
    v_and_b32 v57, 15, v6
    v_lshl_add_u32 v56, v57, 2, v56
    v_lshlrev_b32 v59, 2, v0
    v_mov_b32 v47, 0x3f800000
    v_mov_b32 v20, 0x41800000
    v_cndmask_b32 v20, v20, v47, s[44:45]
    v_mov_b32 v21, 0x0
    v_mul_f32 v40, v10, v20
    v_mul_f32 v41, v11, v20
    v_exp_f32 v40, v40
    v_fract_f32 v41, v41
    v_cos_f32 v42, v41
    v_sin_f32 v43, v41
    s_nop 0
    v_mul_f32 v24, v40, v42
    v_mul_f32 v25, v40, v43
    v_mul_f32 v40, v10, v21
    v_mul_f32 v41, v11, v21
    v_exp_f32 v40, v40
    v_fract_f32 v41, v41
    v_cos_f32 v42, v41
    v_sin_f32 v43, v41
    s_nop 0
    v_mul_f32 v28, v40, v42
    v_mul_f32 v29, v40, v43
    v_mul_f32 v44, v28, v17
    v_mul_f32 v45, v28, v18
    v_fma_f32 v44, -v29, v18, v44
    v_fma_f32 v45, v29, v17, v45
    v_mov_b32 v28, v44
    v_mov_b32 v29, v45
    v_mov_b32 v47, 1.0
    v_cndmask_b32 v28, v28, v47, s[44:45]
    v_mov_b32 v47, 0
    v_cndmask_b32 v29, v29, v47, s[44:45]
    v_mov_b32 v33, -1.0
    v_mov_b32 v47, 1.0
    v_cndmask_b32 v33, v33, v47, s[44:45]
    v_mul_f32 v32, v33, v29
    ds_write_b32 v5, v28 offset:0
    ds_write_b32 v5, v32 offset:68
    v_mul_f32 v44, v28, v24
    v_mul_f32 v45, v28, v25
    v_fma_f32 v44, -v29, v25, v44
    v_fma_f32 v45, v29, v24, v45
    v_mov_b32 v28, v44
    v_mov_b32 v29, v45
    v_mul_f32 v32, v33, v29
    ds_write_b32 v5, v28 offset:4
    ds_write_b32 v5, v32 offset:72
    v_mul_f32 v44, v28, v24
    v_mul_f32 v45, v28, v25
    v_fma_f32 v44, -v29, v25, v44
    v_fma_f32 v45, v29, v24, v45
    v_mov_b32 v28, v44
    v_mov_b32 v29, v45
    v_mul_f32 v32, v33, v29
    ds_write_b32 v5, v28 offset:8
    ds_write_b32 v5, v32 offset:76
    v_mul_f32 v44, v28, v24
    v_mul_f32 v45, v28, v25
    v_fma_f32 v44, -v29, v25, v44
    v_fma_f32 v45, v29, v24, v45
    v_mov_b32 v28, v44
    v_mov_b32 v29, v45
    v_mul_f32 v32, v33, v29
    ds_write_b32 v5, v28 offset:12
    ds_write_b32 v5, v32 offset:80
    v_mul_f32 v44, v28, v24
    v_mul_f32 v45, v28, v25
    v_fma_f32 v44, -v29, v25, v44
    v_fma_f32 v45, v29, v24, v45
    v_mov_b32 v28, v44
    v_mov_b32 v29, v45
    v_mul_f32 v32, v33, v29
    ds_write_b32 v5, v28 offset:16
    ds_write_b32 v5, v32 offset:84
    v_mul_f32 v44, v28, v24
    v_mul_f32 v45, v28, v25
    v_fma_f32 v44, -v29, v25, v44
    v_fma_f32 v45, v29, v24, v45
    v_mov_b32 v28, v44
    v_mov_b32 v29, v45
    v_mul_f32 v32, v33, v29
    ds_write_b32 v5, v28 offset:20
    ds_write_b32 v5, v32 offset:88
    v_mul_f32 v44, v28, v24
    v_mul_f32 v45, v28, v25
    v_fma_f32 v44, -v29, v25, v44
    v_fma_f32 v45, v29, v24, v45
    v_mov_b32 v28, v44
    v_mov_b32 v29, v45
    v_mul_f32 v32, v33, v29
    ds_write_b32 v5, v28 offset:24
    ds_write_b32 v5, v32 offset:92
    v_mul_f32 v44, v28, v24
    v_mul_f32 v45, v28, v25
    v_fma_f32 v44, -v29, v25, v44
    v_fma_f32 v45, v29, v24, v45
    v_mov_b32 v28, v44
    v_mov_b32 v29, v45
    v_mul_f32 v32, v33, v29
    ds_write_b32 v5, v28 offset:28
    ds_write_b32 v5, v32 offset:96
    v_mul_f32 v44, v28, v24
    v_mul_f32 v45, v28, v25
    v_fma_f32 v44, -v29, v25, v44
    v_fma_f32 v45, v29, v24, v45
    v_mov_b32 v28, v44
    v_mov_b32 v29, v45
    v_mul_f32 v32, v33, v29
    ds_write_b32 v5, v28 offset:32
    ds_write_b32 v5, v32 offset:100
    v_mul_f32 v44, v28, v24
    v_mul_f32 v45, v28, v25
    v_fma_f32 v44, -v29, v25, v44
    v_fma_f32 v45, v29, v24, v45
    v_mov_b32 v28, v44
    v_mov_b32 v29, v45
    v_mul_f32 v32, v33, v29
    ds_write_b32 v5, v28 offset:36
    ds_write_b32 v5, v32 offset:104
    v_mul_f32 v44, v28, v24
    v_mul_f32 v45, v28, v25
    v_fma_f32 v44, -v29, v25, v44
    v_fma_f32 v45, v29, v24, v45
    v_mov_b32 v28, v44
    v_mov_b32 v29, v45
    v_mul_f32 v32, v33, v29
    ds_write_b32 v5, v28 offset:40
    ds_write_b32 v5, v32 offset:108
    v_mul_f32 v44, v28, v24
    v_mul_f32 v45, v28, v25
    v_fma_f32 v44, -v29, v25, v44
    v_fma_f32 v45, v29, v24, v45
    v_mov_b32 v28, v44
    v_mov_b32 v29, v45
    v_mul_f32 v32, v33, v29
    ds_write_b32 v5, v28 offset:44
    ds_write_b32 v5, v32 offset:112
    v_mul_f32 v44, v28, v24
    v_mul_f32 v45, v28, v25
    v_fma_f32 v44, -v29, v25, v44
    v_fma_f32 v45, v29, v24, v45
    v_mov_b32 v28, v44
    v_mov_b32 v29, v45
    v_mul_f32 v32, v33, v29
    ds_write_b32 v5, v28 offset:48
    ds_write_b32 v5, v32 offset:116
    v_mul_f32 v44, v28, v24
    v_mul_f32 v45, v28, v25
    v_fma_f32 v44, -v29, v25, v44
    v_fma_f32 v45, v29, v24, v45
    v_mov_b32 v28, v44
    v_mov_b32 v29, v45
    v_mul_f32 v32, v33, v29
    ds_write_b32 v5, v28 offset:52
    ds_write_b32 v5, v32 offset:120
    v_mul_f32 v44, v28, v24
    v_mul_f32 v45, v28, v25
    v_fma_f32 v44, -v29, v25, v44
    v_fma_f32 v45, v29, v24, v45
    v_mov_b32 v28, v44
    v_mov_b32 v29, v45
    v_mul_f32 v32, v33, v29
    ds_write_b32 v5, v28 offset:56
    ds_write_b32 v5, v32 offset:124
    v_mul_f32 v44, v28, v24
    v_mul_f32 v45, v28, v25
    v_fma_f32 v44, -v29, v25, v44
    v_fma_f32 v45, v29, v24, v45
    v_mov_b32 v28, v44
    v_mov_b32 v29, v45
    v_mul_f32 v32, v33, v29
    ds_write_b32 v5, v28 offset:60
    ds_write_b32 v5, v32 offset:128
    s_waitcnt lgkmcnt(0)
    s_barrier
    v_mov_b32 v48, 0
    v_mov_b32 v49, 0
    v_mov_b32 v50, 0
    v_mov_b32 v51, 0
    ds_read_b32 v64, v9 offset:0
    ds_read_b32 v65, v9 offset:17408
    ds_read_b32 v66, v9 offset:272
    ds_read_b32 v67, v9 offset:17680
    ds_read_b32 v68, v9 offset:544
    ds_read_b32 v69, v9 offset:17952
    ds_read_b32 v70, v9 offset:816
    ds_read_b32 v71, v9 offset:18224
    ds_read_b32 v72, v9 offset:1088
    ds_read_b32 v73, v9 offset:18496
    ds_read_b32 v74, v9 offset:1360
    ds_read_b32 v75, v9 offset:18768
    ds_read_b32 v76, v9 offset:1632
    ds_read_b32 v77, v9 offset:19040
    ds_read_b32 v78, v9 offset:1904
    ds_read_b32 v79, v9 offset:19312
    ds_read_b32 v80, v9 offset:2176
    ds_read_b32 v81, v9 offset:19584
    ds_read_b32 v82, v9 offset:2448
    ds_read_b32 v83, v9 offset:19856
    ds_read_b32 v84, v9 offset:2720
    ds_read_b32 v85, v9 offset:20128
    ds_read_b32 v86, v9 offset:2992
    ds_read_b32 v87, v9 offset:20400
    ds_read_b32 v88, v9 offset:3264
    ds_read_b32 v89, v9 offset:20672
    ds_read_b32 v90, v9 offset:3536
    ds_read_b32 v91, v9 offset:20944
    ds_read_b32 v92, v9 offset:3808
    ds_read_b32 v93, v9 offset:21216
    ds_read_b32 v94, v9 offset:4080
    ds_read_b32 v95, v9 offset:21488
    s_waitcnt lgkmcnt(15)
    v_mfma_f32_16x16x4_f32 v[48:51], v64, v65, v[48:51]
    s_waitcnt lgkmcnt(15)
    v_mfma_f32_16x16x4_f32 v[48:51], v66, v67, v[48:51]
    s_waitcnt lgkmcnt(15)
    v_mfma_f32_16x16x4_f32 v[48:51], v68, v69, v[48:51]
    s_waitcnt lgkmcnt(15)
    v_mfma_f32_16x16x4_f32 v[48:51], v70, v71, v[48:51]
    s_waitcnt lgkmcnt(15)
    v_mfma_f32_16x16x4_f32 v[48:51], v72, v73, v[48:51]
    s_waitcnt lgkmcnt(15)
    v_mfma_f32_16x16x4_f32 v[48:51], v74, v75, v[48:51]
    s_waitcnt lgkmcnt(15)
    v_mfma_f32_16x16x4_f32 v[48:51], v76, v77, v[48:51]
    s_waitcnt lgkmcnt(15)
    v_mfma_f32_16x16x4_f32 v[48:51], v78, v79, v[48:51]
    s_waitcnt lgkmcnt(14)
    v_mfma_f32_16x16x4_f32 v[48:51], v80, v81, v[48:51]
    s_waitcnt lgkmcnt(12)
    v_mfma_f32_16x16x4_f32 v[48:51], v82, v83, v[48:51]
    s_waitcnt lgkmcnt(10)
    v_mfma_f32_16x16x4_f32 v[48:51], v84, v85, v[48:51]
    s_waitcnt lgkmcnt(8)
    v_mfma_f32_16x16x4_f32 v[48:51], v86, v87, v[48:51]
    s_waitcnt lgkmcnt(6)
    v_mfma_f32_16x16x4_f32 v[48:51], v88, v89, v[48:51]
    s_waitcnt lgkmcnt(4)
    v_mfma_f32_16x16x4_f32 v[48:51], v90, v91, v[48:51]
    s_waitcnt lgkmcnt(2)
    v_mfma_f32_16x16x4_f32 v[48:51], v92, v93, v[48:51]
    s_waitcnt lgkmcnt(0)
    v_mfma_f32_16x16x4_f32 v[48:51], v94, v95, v[48:51]
    s_nop 15
    s_nop 3
    ds_write_b32 v56, v48 offset:34816
    ds_write_b32 v56, v49 offset:34880
    ds_write_b32 v56, v50 offset:34944
    ds_write_b32 v56, v51 offset:35008
    s_waitcnt lgkmcnt(0)
    s_barrier
    ds_read_b32 v60, v59 offset:34816
    ds_read_b32 v61, v59 offset:35840
    ds_read_b32 v62, v59 offset:36864
    ds_read_b32 v63, v59 offset:37888
    s_waitcnt lgkmcnt(0)
    v_add_f32 v60, v60, v61
    v_add_f32 v62, v62, v63
    v_add_f32 v60, v60, v62
    v_cmp_gt_u32 vcc, 256, v0
    s_and_saveexec_b64 s[48:49], vcc
    ds_write_b32 v59, v60 offset:38912
    s_mov_b64 exec, s[48:49]
    v_mov_b32 v47, 0x40000000
    v_mov_b32 v20, 0x42000000
    v_cndmask_b32 v20, v20, v47, s[44:45]
    v_mov_b32 v21, 0x43800000
    v_mul_f32 v40, v10, v20
    v_mul_f32 v41, v11, v20
    v_exp_f32 v40, v40
    v_fract_f32 v41, v41
    v_cos_f32 v42, v41
    v_sin_f32 v43, v41
    s_nop 0
    v_mul_f32 v24, v40, v42
    v_mul_f32 v25, v40, v43
    v_mul_f32 v40, v10, v21
    v_mul_f32 v41, v11, v21
    v_exp_f32 v40, v40
    v_fract_f32 v41, v41
    v_cos_f32 v42, v41
    v_sin_f32 v43, v41
    s_nop 0
    v_mul_f32 v28, v40, v42
    v_mul_f32 v29, v40, v43
    v_mul_f32 v44, v28, v17
    v_mul_f32 v45, v28, v18
    v_fma_f32 v44, -v29, v18, v44
    v_fma_f32 v45, v29, v17, v45
    v_mov_b32 v28, v44
    v_mov_b32 v29, v45
    v_mov_b32 v47, 1.0
    v_cndmask_b32 v28, v28, v47, s[44:45]
    v_mov_b32 v47, 0
    v_cndmask_b32 v29, v29, v47, s[44:45]
    v_mov_b32 v33, -1.0
    v_mov_b32 v47, 1.0
    v_cndmask_b32 v33, v33, v47, s[44:45]
    s_barrier
    v_mul_f32 v32, v33, v29
    ds_write_b32 v5, v28 offset:0
    ds_write_b32 v5, v32 offset:68
    v_mul_f32 v44, v28, v24
    v_mul_f32 v45, v28, v25
    v_fma_f32 v44, -v29, v25, v44
    v_fma_f32 v45, v29, v24, v45
    v_mov_b32 v28, v44
    v_mov_b32 v29, v45
    v_mul_f32 v32, v33, v29
    ds_write_b32 v5, v28 offset:4
    ds_write_b32 v5, v32 offset:72
    v_mul_f32 v44, v28, v24
    v_mul_f32 v45, v28, v25
    v_fma_f32 v44, -v29, v25, v44
    v_fma_f32 v45, v29, v24, v45
    v_mov_b32 v28, v44
    v_mov_b32 v29, v45
    v_mul_f32 v32, v33, v29
    ds_write_b32 v5, v28 offset:8
    ds_write_b32 v5, v32 offset:76
    v_mul_f32 v44, v28, v24
    v_mul_f32 v45, v28, v25
    v_fma_f32 v44, -v29, v25, v44
    v_fma_f32 v45, v29, v24, v45
    v_mov_b32 v28, v44
    v_mov_b32 v29, v45
    v_mul_f32 v32, v33, v29
    ds_write_b32 v5, v28 offset:12
    ds_write_b32 v5, v32 offset:80
    v_mul_f32 v44, v28, v24
    v_mul_f32 v45, v28, v25
    v_fma_f32 v44, -v29, v25, v44
    v_fma_f32 v45, v29, v24, v45
    v_mov_b32 v28, v44
    v_mov_b32 v29, v45
    v_mul_f32 v32, v33, v29
    ds_write_b32 v5, v28 offset:16
    ds_write_b32 v5, v32 offset:84
    v_mul_f32 v44, v28, v24
    v_mul_f32 v45, v28, v25
    v_fma_f32 v44, -v29, v25, v44
    v_fma_f32 v45, v29, v24, v45
    v_mov_b32 v28, v44
    v_mov_b32 v29, v45
    v_mul_f32 v32, v33, v29
    ds_write_b32 v5, v28 offset:20
    ds_write_b32 v5, v32 offset:88
    v_mul_f32 v44, v28, v24
    v_mul_f32 v45, v28, v25
    v_fma_f32 v44, -v29, v25, v44
    v_fma_f32 v45, v29, v24, v45
    v_mov_b32 v28, v44
    v_mov_b32 v29, v45
    v_mul_f32 v32, v33, v29
    ds_write_b32 v5, v28 offset:24
    ds_write_b32 v5, v32 offset:92
    v_mul_f32 v44, v28, v24
    v_mul_f32 v45, v28, v25
    v_fma_f32 v44, -v29, v25, v44
    v_fma_f32 v45, v29, v24, v45
    v_mov_b32 v28, v44
    v_mov_b32 v29, v45
    v_mul_f32 v32, v33, v29
    ds_write_b32 v5, v28 offset:28
    ds_write_b32 v5, v32 offset:96
    v_mul_f32 v44, v28, v24
    v_mul_f32 v45, v28, v25
    v_fma_f32 v44, -v29, v25, v44
    v_fma_f32 v45, v29, v24, v45
    v_mov_b32 v28, v44
    v_mov_b32 v29, v45
    v_mul_f32 v32, v33, v29
    ds_write_b32 v5, v28 offset:32
    ds_write_b32 v5, v32 offset:100
    v_mul_f32 v44, v28, v24
    v_mul_f32 v45, v28, v25
    v_fma_f32 v44, -v29, v25, v44
    v_fma_f32 v45, v29, v24, v45
    v_mov_b32 v28, v44
    v_mov_b32 v29, v45
    v_mul_f32 v32, v33, v29
    ds_write_b32 v5, v28 offset:36
    ds_write_b32 v5, v32 offset:104
    v_mul_f32 v44, v28, v24
    v_mul_f32 v45, v28, v25
    v_fma_f32 v44, -v29, v25, v44
    v_fma_f32 v45, v29, v24, v45
    v_mov_b32 v28, v44
    v_mov_b32 v29, v45
    v_mul_f32 v32, v33, v29
    ds_write_b32 v5, v28 offset:40
    ds_write_b32 v5, v32 offset:108
    v_mul_f32 v44, v28, v24
    v_mul_f32 v45, v28, v25
    v_fma_f32 v44, -v29, v25, v44
    v_fma_f32 v45, v29, v24, v45
    v_mov_b32 v28, v44
    v_mov_b32 v29, v45
    v_mul_f32 v32, v33, v29
    ds_write_b32 v5, v28 offset:44
    ds_write_b32 v5, v32 offset:112
    v_mul_f32 v44, v28, v24
    v_mul_f32 v45, v28, v25
    v_fma_f32 v44, -v29, v25, v44
    v_fma_f32 v45, v29, v24, v45
    v_mov_b32 v28, v44
    v_mov_b32 v29, v45
    v_mul_f32 v32, v33, v29
    ds_write_b32 v5, v28 offset:48
    ds_write_b32 v5, v32 offset:116
    v_mul_f32 v44, v28, v24
    v_mul_f32 v45, v28, v25
    v_fma_f32 v44, -v29, v25, v44
    v_fma_f32 v45, v29, v24, v45
    v_mov_b32 v28, v44
    v_mov_b32 v29, v45
    v_mul_f32 v32, v33, v29
    ds_write_b32 v5, v28 offset:52
    ds_write_b32 v5, v32 offset:120
    v_mul_f32 v44, v28, v24
    v_mul_f32 v45, v28, v25
    v_fma_f32 v44, -v29, v25, v44
    v_fma_f32 v45, v29, v24, v45
    v_mov_b32 v28, v44
    v_mov_b32 v29, v45
    v_mul_f32 v32, v33, v29
    ds_write_b32 v5, v28 offset:56
    ds_write_b32 v5, v32 offset:124
    v_mul_f32 v44, v28, v24
    v_mul_f32 v45, v28, v25
    v_fma_f32 v44, -v29, v25, v44
    v_fma_f32 v45, v29, v24, v45
    v_mov_b32 v28, v44
    v_mov_b32 v29, v45
    v_mul_f32 v32, v33, v29
    ds_write_b32 v5, v28 offset:60
    ds_write_b32 v5, v32 offset:128
    s_waitcnt lgkmcnt(0)
    s_barrier
    v_mov_b32 v48, 0
    v_mov_b32 v49, 0
    v_mov_b32 v50, 0
    v_mov_b32 v51, 0
    ds_read_b32 v64, v9 offset:0
    ds_read_b32 v65, v9 offset:17408
    ds_read_b32 v66, v9 offset:272
    ds_read_b32 v67, v9 offset:17680
    ds_read_b32 v68, v9 offset:544
    ds_read_b32 v69, v9 offset:17952
    ds_read_b32 v70, v9 offset:816
    ds_read_b32 v71, v9 offset:18224
    ds_read_b32 v72, v9 offset:1088
    ds_read_b32 v73, v9 offset:18496
    ds_read_b32 v74, v9 offset:1360
    ds_read_b32 v75, v9 offset:18768
    ds_read_b32 v76, v9 offset:1632
    ds_read_b32 v77, v9 offset:19040
    ds_read_b32 v78, v9 offset:1904
    ds_read_b32 v79, v9 offset:19312
    ds_read_b32 v80, v9 offset:2176
    ds_read_b32 v81, v9 offset:19584
    ds_read_b32 v82, v9 offset:2448
    ds_read_b32 v83, v9 offset:19856
    ds_read_b32 v84, v9 offset:2720
    ds_read_b32 v85, v9 offset:20128
    ds_read_b32 v86, v9 offset:2992
    ds_read_b32 v87, v9 offset:20400
    ds_read_b32 v88, v9 offset:3264
    ds_read_b32 v89, v9 offset:20672
    ds_read_b32 v90, v9 offset:3536
    ds_read_b32 v91, v9 offset:20944
    ds_read_b32 v92, v9 offset:3808
    ds_read_b32 v93, v9 offset:21216
    ds_read_b32 v94, v9 offset:4080
    ds_read_b32 v95, v9 offset:21488
    s_waitcnt lgkmcnt(15)
    v_mfma_f32_16x16x4_f32 v[48:51], v64, v65, v[48:51]
    s_waitcnt lgkmcnt(15)
    v_mfma_f32_16x16x4_f32 v[48:51], v66, v67, v[48:51]
    s_waitcnt lgkmcnt(15)
    v_mfma_f32_16x16x4_f32 v[48:51], v68, v69, v[48:51]
    s_waitcnt lgkmcnt(15)
    v_mfma_f32_16x16x4_f32 v[48:51], v70, v71, v[48:51]
    s_waitcnt lgkmcnt(15)
    v_mfma_f32_16x16x4_f32 v[48:51], v72, v73, v[48:51]
    s_waitcnt lgkmcnt(15)
    v_mfma_f32_16x16x4_f32 v[48:51], v74, v75, v[48:51]
    s_waitcnt lgkmcnt(15)
    v_mfma_f32_16x16x4_f32 v[48:51], v76, v77, v[48:51]
    s_waitcnt lgkmcnt(15)
    v_mfma_f32_16x16x4_f32 v[48:51], v78, v79, v[48:51]
    s_waitcnt lgkmcnt(14)
    v_mfma_f32_16x16x4_f32 v[48:51], v80, v81, v[48:51]
    s_waitcnt lgkmcnt(12)
    v_mfma_f32_16x16x4_f32 v[48:51], v82, v83, v[48:51]
    s_waitcnt lgkmcnt(10)
    v_mfma_f32_16x16x4_f32 v[48:51], v84, v85, v[48:51]
    s_waitcnt lgkmcnt(8)
    v_mfma_f32_16x16x4_f32 v[48:51], v86, v87, v[48:51]
    s_waitcnt lgkmcnt(6)
    v_mfma_f32_16x16x4_f32 v[48:51], v88, v89, v[48:51]
    s_waitcnt lgkmcnt(4)
    v_mfma_f32_16x16x4_f32 v[48:51], v90, v91, v[48:51]
    s_waitcnt lgkmcnt(2)
    v_mfma_f32_16x16x4_f32 v[48:51], v92, v93, v[48:51]
    s_waitcnt lgkmcnt(0)
    v_mfma_f32_16x16x4_f32 v[48:51], v94, v95, v[48:51]
    s_nop 15
    s_nop 3
    ds_write_b32 v56, v48 offset:34816
    ds_write_b32 v56, v49 offset:34880
    ds_write_b32 v56, v50 offset:34944
    ds_write_b32 v56, v51 offset:35008
    s_waitcnt lgkmcnt(0)
    s_barrier
    ds_read_b32 v60, v59 offset:34816
    ds_read_b32 v61, v59 offset:35840
    ds_read_b32 v62, v59 offset:36864
    ds_read_b32 v63, v59 offset:37888
    s_waitcnt lgkmcnt(0)
    v_add_f32 v60, v60, v61
    v_add_f32 v62, v62, v63
    v_add_f32 v60, v60, v62
    v_cmp_gt_u32 vcc, 128, v0
    s_and_saveexec_b64 s[48:49], vcc
    ds_write_b32 v59, v60 offset:39936
    s_mov_b64 exec, s[48:49]
    v_mov_b32 v47, 0x40800000
    v_mov_b32 v20, 0x42800000
    v_cndmask_b32 v20, v20, v47, s[44:45]
    v_mov_b32 v21, 0x44000000
    v_mul_f32 v40, v10, v20
    v_mul_f32 v41, v11, v20
    v_exp_f32 v40, v40
    v_fract_f32 v41, v41
    v_cos_f32 v42, v41
    v_sin_f32 v43, v41
    s_nop 0
    v_mul_f32 v24, v40, v42
    v_mul_f32 v25, v40, v43
    v_mul_f32 v40, v10, v21
    v_mul_f32 v41, v11, v21
    v_exp_f32 v40, v40
    v_fract_f32 v41, v41
    v_cos_f32 v42, v41
    v_sin_f32 v43, v41
    s_nop 0
    v_mul_f32 v28, v40, v42
    v_mul_f32 v29, v40, v43
    v_mul_f32 v44, v28, v17
    v_mul_f32 v45, v28, v18
    v_fma_f32 v44, -v29, v18, v44
    v_fma_f32 v45, v29, v17, v45
    v_mov_b32 v28, v44
    v_mov_b32 v29, v45
    v_mov_b32 v47, 1.0
    v_cndmask_b32 v28, v28, v47, s[44:45]
    v_mov_b32 v47, 0
    v_cndmask_b32 v29, v29, v47, s[44:45]
    v_mov_b32 v33, -1.0
    v_mov_b32 v47, 1.0
    v_cndmask_b32 v33, v33, v47, s[44:45]
    s_barrier
    v_mul_f32 v32, v33, v29
    ds_write_b32 v5, v28 offset:0
    ds_write_b32 v5, v32 offset:68
    v_mul_f32 v44, v28, v24
    v_mul_f32 v45, v28, v25
    v_fma_f32 v44, -v29, v25, v44
    v_fma_f32 v45, v29, v24, v45
    v_mov_b32 v28, v44
    v_mov_b32 v29, v45
    v_mul_f32 v32, v33, v29
    ds_write_b32 v5, v28 offset:4
    ds_write_b32 v5, v32 offset:72
    v_mul_f32 v44, v28, v24
    v_mul_f32 v45, v28, v25
    v_fma_f32 v44, -v29, v25, v44
    v_fma_f32 v45, v29, v24, v45
    v_mov_b32 v28, v44
    v_mov_b32 v29, v45
    v_mul_f32 v32, v33, v29
    ds_write_b32 v5, v28 offset:8
    ds_write_b32 v5, v32 offset:76
    v_mul_f32 v44, v28, v24
    v_mul_f32 v45, v28, v25
    v_fma_f32 v44, -v29, v25, v44
    v_fma_f32 v45, v29, v24, v45
    v_mov_b32 v28, v44
    v_mov_b32 v29, v45
    v_mul_f32 v32, v33, v29
    ds_write_b32 v5, v28 offset:12
    ds_write_b32 v5, v32 offset:80
    v_mul_f32 v44, v28, v24
    v_mul_f32 v45, v28, v25
    v_fma_f32 v44, -v29, v25, v44
    v_fma_f32 v45, v29, v24, v45
    v_mov_b32 v28, v44
    v_mov_b32 v29, v45
    v_mul_f32 v32, v33, v29
    ds_write_b32 v5, v28 offset:16
    ds_write_b32 v5, v32 offset:84
    v_mul_f32 v44, v28, v24
    v_mul_f32 v45, v28, v25
    v_fma_f32 v44, -v29, v25, v44
    v_fma_f32 v45, v29, v24, v45
    v_mov_b32 v28, v44
    v_mov_b32 v29, v45
    v_mul_f32 v32, v33, v29
    ds_write_b32 v5, v28 offset:20
    ds_write_b32 v5, v32 offset:88
    v_mul_f32 v44, v28, v24
    v_mul_f32 v45, v28, v25
    v_fma_f32 v44, -v29, v25, v44
    v_fma_f32 v45, v29, v24, v45
    v_mov_b32 v28, v44
    v_mov_b32 v29, v45
    v_mul_f32 v32, v33, v29
    ds_write_b32 v5, v28 offset:24
    ds_write_b32 v5, v32 offset:92
    v_mul_f32 v44, v28, v24
    v_mul_f32 v45, v28, v25
    v_fma_f32 v44, -v29, v25, v44
    v_fma_f32 v45, v29, v24, v45
    v_mov_b32 v28, v44
    v_mov_b32 v29, v45
    v_mul_f32 v32, v33, v29
    ds_write_b32 v5, v28 offset:28
    ds_write_b32 v5, v32 offset:96
    v_mul_f32 v44, v28, v24
    v_mul_f32 v45, v28, v25
    v_fma_f32 v44, -v29, v25, v44
    v_fma_f32 v45, v29, v24, v45
    v_mov_b32 v28, v44
    v_mov_b32 v29, v45
    v_mul_f32 v32, v33, v29
    ds_write_b32 v5, v28 offset:32
    ds_write_b32 v5, v32 offset:100
    v_mul_f32 v44, v28, v24
    v_mul_f32 v45, v28, v25
    v_fma_f32 v44, -v29, v25, v44
    v_fma_f32 v45, v29, v24, v45
    v_mov_b32 v28, v44
    v_mov_b32 v29, v45
    v_mul_f32 v32, v33, v29
    ds_write_b32 v5, v28 offset:36
    ds_write_b32 v5, v32 offset:104
    v_mul_f32 v44, v28, v24
    v_mul_f32 v45, v28, v25
    v_fma_f32 v44, -v29, v25, v44
    v_fma_f32 v45, v29, v24, v45
    v_mov_b32 v28, v44
    v_mov_b32 v29, v45
    v_mul_f32 v32, v33, v29
    ds_write_b32 v5, v28 offset:40
    ds_write_b32 v5, v32 offset:108
    v_mul_f32 v44, v28, v24
    v_mul_f32 v45, v28, v25
    v_fma_f32 v44, -v29, v25, v44
    v_fma_f32 v45, v29, v24, v45
    v_mov_b32 v28, v44
    v_mov_b32 v29, v45
    v_mul_f32 v32, v33, v29
    ds_write_b32 v5, v28 offset:44
    ds_write_b32 v5, v32 offset:112
    v_mul_f32 v44, v28, v24
    v_mul_f32 v45, v28, v25
    v_fma_f32 v44, -v29, v25, v44
    v_fma_f32 v45, v29, v24, v45
    v_mov_b32 v28, v44
    v_mov_b32 v29, v45
    v_mul_f32 v32, v33, v29
    ds_write_b32 v5, v28 offset:48
    ds_write_b32 v5, v32 offset:116
    v_mul_f32 v44, v28, v24
    v_mul_f32 v45, v28, v25
    v_fma_f32 v44, -v29, v25, v44
    v_fma_f32 v45, v29, v24, v45
    v_mov_b32 v28, v44
    v_mov_b32 v29, v45
    v_mul_f32 v32, v33, v29
    ds_write_b32 v5, v28 offset:52
    ds_write_b32 v5, v32 offset:120
    v_mul_f32 v44, v28, v24
    v_mul_f32 v45, v28, v25
    v_fma_f32 v44, -v29, v25, v44
    v_fma_f32 v45, v29, v24, v45
    v_mov_b32 v28, v44
    v_mov_b32 v29, v45
    v_mul_f32 v32, v33, v29
    ds_write_b32 v5, v28 offset:56
    ds_write_b32 v5, v32 offset:124
    v_mul_f32 v44, v28, v24
    v_mul_f32 v45, v28, v25
    v_fma_f32 v44, -v29, v25, v44
    v_fma_f32 v45, v29, v24, v45
    v_mov_b32 v28, v44
    v_mov_b32 v29, v45
    v_mul_f32 v32, v33, v29
    ds_write_b32 v5, v28 offset:60
    ds_write_b32 v5, v32 offset:128
    s_waitcnt lgkmcnt(0)
    s_barrier
    v_mov_b32 v48, 0
    v_mov_b32 v49, 0
    v_mov_b32 v50, 0
    v_mov_b32 v51, 0
    ds_read_b32 v64, v9 offset:0
    ds_read_b32 v65, v9 offset:17408
    ds_read_b32 v66, v9 offset:272
    ds_read_b32 v67, v9 offset:17680
    ds_read_b32 v68, v9 offset:544
    ds_read_b32 v69, v9 offset:17952
    ds_read_b32 v70, v9 offset:816
    ds_read_b32 v71, v9 offset:18224
    ds_read_b32 v72, v9 offset:1088
    ds_read_b32 v73, v9 offset:18496
    ds_read_b32 v74, v9 offset:1360
    ds_read_b32 v75, v9 offset:18768
    ds_read_b32 v76, v9 offset:1632
    ds_read_b32 v77, v9 offset:19040
    ds_read_b32 v78, v9 offset:1904
    ds_read_b32 v79, v9 offset:19312
    ds_read_b32 v80, v9 offset:2176
    ds_read_b32 v81, v9 offset:19584
    ds_read_b32 v82, v9 offset:2448
    ds_read_b32 v83, v9 offset:19856
    ds_read_b32 v84, v9 offset:2720
    ds_read_b32 v85, v9 offset:20128
    ds_read_b32 v86, v9 offset:2992
    ds_read_b32 v87, v9 offset:20400
    ds_read_b32 v88, v9 offset:3264
    ds_read_b32 v89, v9 offset:20672
    ds_read_b32 v90, v9 offset:3536
    ds_read_b32 v91, v9 offset:20944
    ds_read_b32 v92, v9 offset:3808
    ds_read_b32 v93, v9 offset:21216
    ds_read_b32 v94, v9 offset:4080
    ds_read_b32 v95, v9 offset:21488
    s_waitcnt lgkmcnt(15)
    v_mfma_f32_16x16x4_f32 v[48:51], v64, v65, v[48:51]
    s_waitcnt lgkmcnt(15)
    v_mfma_f32_16x16x4_f32 v[48:51], v66, v67, v[48:51]
    s_waitcnt lgkmcnt(15)
    v_mfma_f32_16x16x4_f32 v[48:51], v68, v69, v[48:51]
    s_waitcnt lgkmcnt(15)
    v_mfma_f32_16x16x4_f32 v[48:51], v70, v71, v[48:51]
    s_waitcnt lgkmcnt(15)
    v_mfma_f32_16x16x4_f32 v[48:51], v72, v73, v[48:51]
    s_waitcnt lgkmcnt(15)
    v_mfma_f32_16x16x4_f32 v[48:51], v74, v75, v[48:51]
    s_waitcnt lgkmcnt(15)
    v_mfma_f32_16x16x4_f32 v[48:51], v76, v77, v[48:51]
    s_waitcnt lgkmcnt(15)
    v_mfma_f32_16x16x4_f32 v[48:51], v78, v79, v[48:51]
    s_waitcnt lgkmcnt(14)
    v_mfma_f32_16x16x4_f32 v[48:51], v80, v81, v[48:51]
    s_waitcnt lgkmcnt(12)
    v_mfma_f32_16x16x4_f32 v[48:51], v82, v83, v[48:51]
    s_waitcnt lgkmcnt(10)
    v_mfma_f32_16x16x4_f32 v[48:51], v84, v85, v[48:51]
    s_waitcnt lgkmcnt(8)
    v_mfma_f32_16x16x4_f32 v[48:51], v86, v87, v[48:51]
    s_waitcnt lgkmcnt(6)
    v_mfma_f32_16x16x4_f32 v[48:51], v88, v89, v[48:51]
    s_waitcnt lgkmcnt(4)
    v_mfma_f32_16x16x4_f32 v[48:51], v90, v91, v[48:51]
    s_waitcnt lgkmcnt(2)
    v_mfma_f32_16x16x4_f32 v[48:51], v92, v93, v[48:51]
    s_waitcnt lgkmcnt(0)
    v_mfma_f32_16x16x4_f32 v[48:51], v94, v95, v[48:51]
    s_nop 15
    s_nop 3
    ds_write_b32 v56, v48 offset:34816
    ds_write_b32 v56, v49 offset:34880
    ds_write_b32 v56, v50 offset:34944
    ds_write_b32 v56, v51 offset:35008
    s_waitcnt lgkmcnt(0)
    s_barrier
    ds_read_b32 v60, v59 offset:34816
    ds_read_b32 v61, v59 offset:35840
    ds_read_b32 v62, v59 offset:36864
    ds_read_b32 v63, v59 offset:37888
    s_waitcnt lgkmcnt(0)
    v_add_f32 v60, v60, v61
    v_add_f32 v62, v62, v63
    v_add_f32 v60, v60, v62
    v_cmp_gt_u32 vcc, 128, v0
    s_and_saveexec_b64 s[48:49], vcc
    ds_write_b32 v59, v60 offset:40448
    s_mov_b64 exec, s[48:49]
    v_mov_b32 v47, 0x41000000
    v_mov_b32 v20, 0x43000000
    v_cndmask_b32 v20, v20, v47, s[44:45]
    v_mov_b32 v21, 0x44800000
    v_mul_f32 v40, v10, v20
    v_mul_f32 v41, v11, v20
    v_exp_f32 v40, v40
    v_fract_f32 v41, v41
    v_cos_f32 v42, v41
    v_sin_f32 v43, v41
    s_nop 0
    v_mul_f32 v24, v40, v42
    v_mul_f32 v25, v40, v43
    v_mul_f32 v40, v10, v21
    v_mul_f32 v41, v11, v21
    v_exp_f32 v40, v40
    v_fract_f32 v41, v41
    v_cos_f32 v42, v41
    v_sin_f32 v43, v41
    s_nop 0
    v_mul_f32 v28, v40, v42
    v_mul_f32 v29, v40, v43
    v_mul_f32 v44, v28, v17
    v_mul_f32 v45, v28, v18
    v_fma_f32 v44, -v29, v18, v44
    v_fma_f32 v45, v29, v17, v45
    v_mov_b32 v28, v44
    v_mov_b32 v29, v45
    v_mov_b32 v47, 1.0
    v_cndmask_b32 v28, v28, v47, s[44:45]
    v_mov_b32 v47, 0
    v_cndmask_b32 v29, v29, v47, s[44:45]
    v_mov_b32 v33, -1.0
    v_mov_b32 v47, 1.0
    v_cndmask_b32 v33, v33, v47, s[44:45]
    s_barrier
    v_mul_f32 v32, v33, v29
    ds_write_b32 v5, v28 offset:0
    ds_write_b32 v5, v32 offset:68
    v_mul_f32 v44, v28, v24
    v_mul_f32 v45, v28, v25
    v_fma_f32 v44, -v29, v25, v44
    v_fma_f32 v45, v29, v24, v45
    v_mov_b32 v28, v44
    v_mov_b32 v29, v45
    v_mul_f32 v32, v33, v29
    ds_write_b32 v5, v28 offset:4
    ds_write_b32 v5, v32 offset:72
    v_mul_f32 v44, v28, v24
    v_mul_f32 v45, v28, v25
    v_fma_f32 v44, -v29, v25, v44
    v_fma_f32 v45, v29, v24, v45
    v_mov_b32 v28, v44
    v_mov_b32 v29, v45
    v_mul_f32 v32, v33, v29
    ds_write_b32 v5, v28 offset:8
    ds_write_b32 v5, v32 offset:76
    v_mul_f32 v44, v28, v24
    v_mul_f32 v45, v28, v25
    v_fma_f32 v44, -v29, v25, v44
    v_fma_f32 v45, v29, v24, v45
    v_mov_b32 v28, v44
    v_mov_b32 v29, v45
    v_mul_f32 v32, v33, v29
    ds_write_b32 v5, v28 offset:12
    ds_write_b32 v5, v32 offset:80
    v_mul_f32 v44, v28, v24
    v_mul_f32 v45, v28, v25
    v_fma_f32 v44, -v29, v25, v44
    v_fma_f32 v45, v29, v24, v45
    v_mov_b32 v28, v44
    v_mov_b32 v29, v45
    v_mul_f32 v32, v33, v29
    ds_write_b32 v5, v28 offset:16
    ds_write_b32 v5, v32 offset:84
    v_mul_f32 v44, v28, v24
    v_mul_f32 v45, v28, v25
    v_fma_f32 v44, -v29, v25, v44
    v_fma_f32 v45, v29, v24, v45
    v_mov_b32 v28, v44
    v_mov_b32 v29, v45
    v_mul_f32 v32, v33, v29
    ds_write_b32 v5, v28 offset:20
    ds_write_b32 v5, v32 offset:88
    v_mul_f32 v44, v28, v24
    v_mul_f32 v45, v28, v25
    v_fma_f32 v44, -v29, v25, v44
    v_fma_f32 v45, v29, v24, v45
    v_mov_b32 v28, v44
    v_mov_b32 v29, v45
    v_mul_f32 v32, v33, v29
    ds_write_b32 v5, v28 offset:24
    ds_write_b32 v5, v32 offset:92
    v_mul_f32 v44, v28, v24
    v_mul_f32 v45, v28, v25
    v_fma_f32 v44, -v29, v25, v44
    v_fma_f32 v45, v29, v24, v45
    v_mov_b32 v28, v44
    v_mov_b32 v29, v45
    v_mul_f32 v32, v33, v29
    ds_write_b32 v5, v28 offset:28
    ds_write_b32 v5, v32 offset:96
    v_mul_f32 v44, v28, v24
    v_mul_f32 v45, v28, v25
    v_fma_f32 v44, -v29, v25, v44
    v_fma_f32 v45, v29, v24, v45
    v_mov_b32 v28, v44
    v_mov_b32 v29, v45
    v_mul_f32 v32, v33, v29
    ds_write_b32 v5, v28 offset:32
    ds_write_b32 v5, v32 offset:100
    v_mul_f32 v44, v28, v24
    v_mul_f32 v45, v28, v25
    v_fma_f32 v44, -v29, v25, v44
    v_fma_f32 v45, v29, v24, v45
    v_mov_b32 v28, v44
    v_mov_b32 v29, v45
    v_mul_f32 v32, v33, v29
    ds_write_b32 v5, v28 offset:36
    ds_write_b32 v5, v32 offset:104
    v_mul_f32 v44, v28, v24
    v_mul_f32 v45, v28, v25
    v_fma_f32 v44, -v29, v25, v44
    v_fma_f32 v45, v29, v24, v45
    v_mov_b32 v28, v44
    v_mov_b32 v29, v45
    v_mul_f32 v32, v33, v29
    ds_write_b32 v5, v28 offset:40
    ds_write_b32 v5, v32 offset:108
    v_mul_f32 v44, v28, v24
    v_mul_f32 v45, v28, v25
    v_fma_f32 v44, -v29, v25, v44
    v_fma_f32 v45, v29, v24, v45
    v_mov_b32 v28, v44
    v_mov_b32 v29, v45
    v_mul_f32 v32, v33, v29
    ds_write_b32 v5, v28 offset:44
    ds_write_b32 v5, v32 offset:112
    v_mul_f32 v44, v28, v24
    v_mul_f32 v45, v28, v25
    v_fma_f32 v44, -v29, v25, v44
    v_fma_f32 v45, v29, v24, v45
    v_mov_b32 v28, v44
    v_mov_b32 v29, v45
    v_mul_f32 v32, v33, v29
    ds_write_b32 v5, v28 offset:48
    ds_write_b32 v5, v32 offset:116
    v_mul_f32 v44, v28, v24
    v_mul_f32 v45, v28, v25
    v_fma_f32 v44, -v29, v25, v44
    v_fma_f32 v45, v29, v24, v45
    v_mov_b32 v28, v44
    v_mov_b32 v29, v45
    v_mul_f32 v32, v33, v29
    ds_write_b32 v5, v28 offset:52
    ds_write_b32 v5, v32 offset:120
    v_mul_f32 v44, v28, v24
    v_mul_f32 v45, v28, v25
    v_fma_f32 v44, -v29, v25, v44
    v_fma_f32 v45, v29, v24, v45
    v_mov_b32 v28, v44
    v_mov_b32 v29, v45
    v_mul_f32 v32, v33, v29
    ds_write_b32 v5, v28 offset:56
    ds_write_b32 v5, v32 offset:124
    v_mul_f32 v44, v28, v24
    v_mul_f32 v45, v28, v25
    v_fma_f32 v44, -v29, v25, v44
    v_fma_f32 v45, v29, v24, v45
    v_mov_b32 v28, v44
    v_mov_b32 v29, v45
    v_mul_f32 v32, v33, v29
    ds_write_b32 v5, v28 offset:60
    ds_write_b32 v5, v32 offset:128
    s_waitcnt lgkmcnt(0)
    s_barrier
    v_mov_b32 v48, 0
    v_mov_b32 v49, 0
    v_mov_b32 v50, 0
    v_mov_b32 v51, 0
    ds_read_b32 v64, v9 offset:0
    ds_read_b32 v65, v9 offset:17408
    ds_read_b32 v66, v9 offset:272
    ds_read_b32 v67, v9 offset:17680
    ds_read_b32 v68, v9 offset:544
    ds_read_b32 v69, v9 offset:17952
    ds_read_b32 v70, v9 offset:816
    ds_read_b32 v71, v9 offset:18224
    ds_read_b32 v72, v9 offset:1088
    ds_read_b32 v73, v9 offset:18496
    ds_read_b32 v74, v9 offset:1360
    ds_read_b32 v75, v9 offset:18768
    ds_read_b32 v76, v9 offset:1632
    ds_read_b32 v77, v9 offset:19040
    ds_read_b32 v78, v9 offset:1904
    ds_read_b32 v79, v9 offset:19312
    ds_read_b32 v80, v9 offset:2176
    ds_read_b32 v81, v9 offset:19584
    ds_read_b32 v82, v9 offset:2448
    ds_read_b32 v83, v9 offset:19856
    ds_read_b32 v84, v9 offset:2720
    ds_read_b32 v85, v9 offset:20128
    ds_read_b32 v86, v9 offset:2992
    ds_read_b32 v87, v9 offset:20400
    ds_read_b32 v88, v9 offset:3264
    ds_read_b32 v89, v9 offset:20672
    ds_read_b32 v90, v9 offset:3536
    ds_read_b32 v91, v9 offset:20944
    ds_read_b32 v92, v9 offset:3808
    ds_read_b32 v93, v9 offset:21216
    ds_read_b32 v94, v9 offset:4080
    ds_read_b32 v95, v9 offset:21488
    s_waitcnt lgkmcnt(15)
    v_mfma_f32_16x16x4_f32 v[48:51], v64, v65, v[48:51]
    s_waitcnt lgkmcnt(15)
    v_mfma_f32_16x16x4_f32 v[48:51], v66, v67, v[48:51]
    s_waitcnt lgkmcnt(15)
    v_mfma_f32_16x16x4_f32 v[48:51], v68, v69, v[48:51]
    s_waitcnt lgkmcnt(15)
    v_mfma_f32_16x16x4_f32 v[48:51], v70, v71, v[48:51]
    s_waitcnt lgkmcnt(15)
    v_mfma_f32_16x16x4_f32 v[48:51], v72, v73, v[48:51]
    s_waitcnt lgkmcnt(15)
    v_mfma_f32_16x16x4_f32 v[48:51], v74, v75, v[48:51]
    s_waitcnt lgkmcnt(15)
    v_mfma_f32_16x16x4_f32 v[48:51], v76, v77, v[48:51]
    s_waitcnt lgkmcnt(15)
    v_mfma_f32_16x16x4_f32 v[48:51], v78, v79, v[48:51]
    s_waitcnt lgkmcnt(14)
    v_mfma_f32_16x16x4_f32 v[48:51], v80, v81, v[48:51]
    s_waitcnt lgkmcnt(12)
    v_mfma_f32_16x16x4_f32 v[48:51], v82, v83, v[48:51]
    s_waitcnt lgkmcnt(10)
    v_mfma_f32_16x16x4_f32 v[48:51], v84, v85, v[48:51]
    s_waitcnt lgkmcnt(8)
    v_mfma_f32_16x16x4_f32 v[48:51], v86, v87, v[48:51]
    s_waitcnt lgkmcnt(6)
    v_mfma_f32_16x16x4_f32 v[48:51], v88, v89, v[48:51]
    s_waitcnt lgkmcnt(4)
    v_mfma_f32_16x16x4_f32 v[48:51], v90, v91, v[48:51]
    s_waitcnt lgkmcnt(2)
    v_mfma_f32_16x16x4_f32 v[48:51], v92, v93, v[48:51]
    s_waitcnt lgkmcnt(0)
    v_mfma_f32_16x16x4_f32 v[48:51], v94, v95, v[48:51]
    s_nop 15
    s_nop 3
    ds_write_b32 v56, v48 offset:34816
    ds_write_b32 v56, v49 offset:34880
    ds_write_b32 v56, v50 offset:34944
    ds_write_b32 v56, v51 offset:35008
    s_waitcnt lgkmcnt(0)
    s_barrier
    ds_read_b32 v60, v59 offset:34816
    ds_read_b32 v61, v59 offset:35840
    ds_read_b32 v62, v59 offset:36864
    ds_read_b32 v63, v59 offset:37888
    s_waitcnt lgkmcnt(0)
    v_add_f32 v60, v60, v61
    v_add_f32 v62, v62, v63
    v_add_f32 v60, v60, v62
    v_cmp_gt_u32 vcc, 129, v0
    s_and_saveexec_b64 s[48:49], vcc
    ds_write_b32 v59, v60 offset:40960
    s_mov_b64 exec, s[48:49]
    s_waitcnt lgkmcnt(0)
    s_barrier
    s_mul_i32 s50, s3, 4192
    s_add_u32 s50, s50, 3145728
    v_add_u32 v60, 0, v0
    v_sub_u32 v61, 2047, v60
    v_max_i32 v62, 0, v61
    v_cvt_f32_u32 v62, v62
    v_cvt_pk_bf16_f32 v62, v62, v62
    v_lshlrev_b32 v62, 16, v62
    v_cvt_u32_f32 v62, v62
    v_mov_b32 v63, v62
    v_subrev_u32 v64, 256, v62
    v_lshrrev_b32 v64, 1, v64
    v_add_u32 v64, 256, v64
    v_cmp_le_u32 vcc, 256, v62
    s_nop 1
    v_cndmask_b32 v63, v63, v64, vcc
    v_subrev_u32 v64, 512, v62
    v_lshrrev_b32 v64, 2, v64
    v_add_u32 v64, 384, v64
    v_cmp_le_u32 vcc, 512, v62
    s_nop 1
    v_cndmask_b32 v63, v63, v64, vcc
    v_subrev_u32 v64, 1024, v62
    v_lshrrev_b32 v64, 3, v64
    v_add_u32 v64, 512, v64
    v_cmp_le_u32 vcc, 1024, v62
    s_nop 1
    v_cndmask_b32 v63, v63, v64, vcc
    v_lshlrev_b32 v63, 2, v63
    ds_read_b32 v70, v63 offset:38912
    v_add_u32 v60, 256, v0
    v_sub_u32 v61, 2047, v60
    v_max_i32 v62, 0, v61
    v_cvt_f32_u32 v62, v62
    v_cvt_pk_bf16_f32 v62, v62, v62
    v_lshlrev_b32 v62, 16, v62
    v_cvt_u32_f32 v62, v62
    v_mov_b32 v63, v62
    v_subrev_u32 v64, 256, v62
    v_lshrrev_b32 v64, 1, v64
    v_add_u32 v64, 256, v64
    v_cmp_le_u32 vcc, 256, v62
    s_nop 1
    v_cndmask_b32 v63, v63, v64, vcc
    v_subrev_u32 v64, 512, v62
    v_lshrrev_b32 v64, 2, v64
    v_add_u32 v64, 384, v64
    v_cmp_le_u32 vcc, 512, v62
    s_nop 1
    v_cndmask_b32 v63, v63, v64, vcc
    v_subrev_u32 v64, 1024, v62
    v_lshrrev_b32 v64, 3, v64
    v_add_u32 v64, 512, v64
    v_cmp_le_u32 vcc, 1024, v62
    s_nop 1
    v_cndmask_b32 v63, v63, v64, vcc
    v_lshlrev_b32 v63, 2, v63
    ds_read_b32 v71, v63 offset:38912
    v_add_u32 v60, 512, v0
    v_sub_u32 v61, 2047, v60
    v_max_i32 v62, 0, v61
    v_cvt_f32_u32 v62, v62
    v_cvt_pk_bf16_f32 v62, v62, v62
    v_lshlrev_b32 v62, 16, v62
    v_cvt_u32_f32 v62, v62
    v_mov_b32 v63, v62
    v_subrev_u32 v64, 256, v62
    v_lshrrev_b32 v64, 1, v64
    v_add_u32 v64, 256, v64
    v_cmp_le_u32 vcc, 256, v62
    s_nop 1
    v_cndmask_b32 v63, v63, v64, vcc
    v_subrev_u32 v64, 512, v62
    v_lshrrev_b32 v64, 2, v64
    v_add_u32 v64, 384, v64
    v_cmp_le_u32 vcc, 512, v62
    s_nop 1
    v_cndmask_b32 v63, v63, v64, vcc
    v_subrev_u32 v64, 1024, v62
    v_lshrrev_b32 v64, 3, v64
    v_add_u32 v64, 512, v64
    v_cmp_le_u32 vcc, 1024, v62
    s_nop 1
    v_cndmask_b32 v63, v63, v64, vcc
    v_lshlrev_b32 v63, 2, v63
    ds_read_b32 v72, v63 offset:38912
    v_add_u32 v60, 768, v0
    v_sub_u32 v61, 2047, v60
    v_max_i32 v62, 0, v61
    v_cvt_f32_u32 v62, v62
    v_cvt_pk_bf16_f32 v62, v62, v62
    v_lshlrev_b32 v62, 16, v62
    v_cvt_u32_f32 v62, v62
    v_mov_b32 v63, v62
    v_subrev_u32 v64, 256, v62
    v_lshrrev_b32 v64, 1, v64
    v_add_u32 v64, 256, v64
    v_cmp_le_u32 vcc, 256, v62
    s_nop 1
    v_cndmask_b32 v63, v63, v64, vcc
    v_subrev_u32 v64, 512, v62
    v_lshrrev_b32 v64, 2, v64
    v_add_u32 v64, 384, v64
    v_cmp_le_u32 vcc, 512, v62
    s_nop 1
    v_cndmask_b32 v63, v63, v64, vcc
    v_subrev_u32 v64, 1024, v62
    v_lshrrev_b32 v64, 3, v64
    v_add_u32 v64, 512, v64
    v_cmp_le_u32 vcc, 1024, v62
    s_nop 1
    v_cndmask_b32 v63, v63, v64, vcc
    v_lshlrev_b32 v63, 2, v63
    ds_read_b32 v73, v63 offset:38912
    v_add_u32 v60, 1024, v0
    v_sub_u32 v61, 2047, v60
    v_max_i32 v62, 0, v61
    v_cvt_f32_u32 v62, v62
    v_cvt_pk_bf16_f32 v62, v62, v62
    v_lshlrev_b32 v62, 16, v62
    v_cvt_u32_f32 v62, v62
    v_mov_b32 v63, v62
    v_subrev_u32 v64, 256, v62
    v_lshrrev_b32 v64, 1, v64
    v_add_u32 v64, 256, v64
    v_cmp_le_u32 vcc, 256, v62
    s_nop 1
    v_cndmask_b32 v63, v63, v64, vcc
    v_subrev_u32 v64, 512, v62
    v_lshrrev_b32 v64, 2, v64
    v_add_u32 v64, 384, v64
    v_cmp_le_u32 vcc, 512, v62
    s_nop 1
    v_cndmask_b32 v63, v63, v64, vcc
    v_subrev_u32 v64, 1024, v62
    v_lshrrev_b32 v64, 3, v64
    v_add_u32 v64, 512, v64
    v_cmp_le_u32 vcc, 1024, v62
    s_nop 1
    v_cndmask_b32 v63, v63, v64, vcc
    v_lshlrev_b32 v63, 2, v63
    ds_read_b32 v74, v63 offset:38912
    v_add_u32 v60, 1280, v0
    v_sub_u32 v61, 2047, v60
    v_max_i32 v62, 0, v61
    v_cvt_f32_u32 v62, v62
    v_cvt_pk_bf16_f32 v62, v62, v62
    v_lshlrev_b32 v62, 16, v62
    v_cvt_u32_f32 v62, v62
    v_mov_b32 v63, v62
    v_subrev_u32 v64, 256, v62
    v_lshrrev_b32 v64, 1, v64
    v_add_u32 v64, 256, v64
    v_cmp_le_u32 vcc, 256, v62
    s_nop 1
    v_cndmask_b32 v63, v63, v64, vcc
    v_subrev_u32 v64, 512, v62
    v_lshrrev_b32 v64, 2, v64
    v_add_u32 v64, 384, v64
    v_cmp_le_u32 vcc, 512, v62
    s_nop 1
    v_cndmask_b32 v63, v63, v64, vcc
    v_subrev_u32 v64, 1024, v62
    v_lshrrev_b32 v64, 3, v64
    v_add_u32 v64, 512, v64
    v_cmp_le_u32 vcc, 1024, v62
    s_nop 1
    v_cndmask_b32 v63, v63, v64, vcc
    v_lshlrev_b32 v63, 2, v63
    ds_read_b32 v75, v63 offset:38912
    v_add_u32 v60, 1536, v0
    v_sub_u32 v61, 2047, v60
    v_max_i32 v62, 0, v61
    v_cvt_f32_u32 v62, v62
    v_cvt_pk_bf16_f32 v62, v62, v62
    v_lshlrev_b32 v62, 16, v62
    v_cvt_u32_f32 v62, v62
    v_mov_b32 v63, v62
    v_subrev_u32 v64, 256, v62
    v_lshrrev_b32 v64, 1, v64
    v_add_u32 v64, 256, v64
    v_cmp_le_u32 vcc, 256, v62
    s_nop 1
    v_cndmask_b32 v63, v63, v64, vcc
    v_subrev_u32 v64, 512, v62
    v_lshrrev_b32 v64, 2, v64
    v_add_u32 v64, 384, v64
    v_cmp_le_u32 vcc, 512, v62
    s_nop 1
    v_cndmask_b32 v63, v63, v64, vcc
    v_subrev_u32 v64, 1024, v62
    v_lshrrev_b32 v64, 3, v64
    v_add_u32 v64, 512, v64
    v_cmp_le_u32 vcc, 1024, v62
    s_nop 1
    v_cndmask_b32 v63, v63, v64, vcc
    v_lshlrev_b32 v63, 2, v63
    ds_read_b32 v76, v63 offset:38912
    v_add_u32 v60, 1792, v0
    v_sub_u32 v61, 2047, v60
    v_max_i32 v62, 0, v61
    v_cvt_f32_u32 v62, v62
    v_cvt_pk_bf16_f32 v62, v62, v62
    v_lshlrev_b32 v62, 16, v62
    v_cvt_u32_f32 v62, v62
    v_mov_b32 v63, v62
    v_subrev_u32 v64, 256, v62
    v_lshrrev_b32 v64, 1, v64
    v_add_u32 v64, 256, v64
    v_cmp_le_u32 vcc, 256, v62
    s_nop 1
    v_cndmask_b32 v63, v63, v64, vcc
    v_subrev_u32 v64, 512, v62
    v_lshrrev_b32 v64, 2, v64
    v_add_u32 v64, 384, v64
    v_cmp_le_u32 vcc, 512, v62
    s_nop 1
    v_cndmask_b32 v63, v63, v64, vcc
    v_subrev_u32 v64, 1024, v62
    v_lshrrev_b32 v64, 3, v64
    v_add_u32 v64, 512, v64
    v_cmp_le_u32 vcc, 1024, v62
    s_nop 1
    v_cndmask_b32 v63, v63, v64, vcc
    v_lshlrev_b32 v63, 2, v63
    ds_read_b32 v77, v63 offset:38912
    v_add_u32 v60, 2048, v0
    v_sub_u32 v61, 2047, v60
    v_max_i32 v62, 0, v61
    v_cvt_f32_u32 v62, v62
    v_cvt_pk_bf16_f32 v62, v62, v62
    v_lshlrev_b32 v62, 16, v62
    v_cvt_u32_f32 v62, v62
    v_mov_b32 v63, v62
    v_subrev_u32 v64, 256, v62
    v_lshrrev_b32 v64, 1, v64
    v_add_u32 v64, 256, v64
    v_cmp_le_u32 vcc, 256, v62
    s_nop 1
    v_cndmask_b32 v63, v63, v64, vcc
    v_subrev_u32 v64, 512, v62
    v_lshrrev_b32 v64, 2, v64
    v_add_u32 v64, 384, v64
    v_cmp_le_u32 vcc, 512, v62
    s_nop 1
    v_cndmask_b32 v63, v63, v64, vcc
    v_subrev_u32 v64, 1024, v62
    v_lshrrev_b32 v64, 3, v64
    v_add_u32 v64, 512, v64
    v_cmp_le_u32 vcc, 1024, v62
    s_nop 1
    v_cndmask_b32 v63, v63, v64, vcc
    v_lshlrev_b32 v63, 2, v63
    ds_read_b32 v78, v63 offset:38912
    s_waitcnt lgkmcnt(0)
    v_add_u32 v60, 0, v0
    v_sub_u32 v61, 2047, v60
    v_cmp_gt_i32 vcc, 0, v61
    s_nop 1
    v_cndmask_b32 v64, v70, 0, vcc
    v_cvt_pk_bf16_f32 v64, v64, v64
    v_lshlrev_b32 v65, 1, v60
    v_cmp_gt_u32 vcc, 2096, v60
    s_and_saveexec_b64 s[48:49], vcc
    buffer_store_short v64, v65, s[20:23], s50 offen
    s_mov_b64 exec, s[48:49]
    v_add_u32 v60, 256, v0
    v_sub_u32 v61, 2047, v60
    v_cmp_gt_i32 vcc, 0, v61
    s_nop 1
    v_cndmask_b32 v64, v71, 0, vcc
    v_cvt_pk_bf16_f32 v64, v64, v64
    v_lshlrev_b32 v65, 1, v60
    v_cmp_gt_u32 vcc, 2096, v60
    s_and_saveexec_b64 s[48:49], vcc
    buffer_store_short v64, v65, s[20:23], s50 offen
    s_mov_b64 exec, s[48:49]
    v_add_u32 v60, 512, v0
    v_sub_u32 v61, 2047, v60
    v_cmp_gt_i32 vcc, 0, v61
    s_nop 1
    v_cndmask_b32 v64, v72, 0, vcc
    v_cvt_pk_bf16_f32 v64, v64, v64
    v_lshlrev_b32 v65, 1, v60
    v_cmp_gt_u32 vcc, 2096, v60
    s_and_saveexec_b64 s[48:49], vcc
    buffer_store_short v64, v65, s[20:23], s50 offen
    s_mov_b64 exec, s[48:49]
    v_add_u32 v60, 768, v0
    v_sub_u32 v61, 2047, v60
    v_cmp_gt_i32 vcc, 0, v61
    s_nop 1
    v_cndmask_b32 v64, v73, 0, vcc
    v_cvt_pk_bf16_f32 v64, v64, v64
    v_lshlrev_b32 v65, 1, v60
    v_cmp_gt_u32 vcc, 2096, v60
    s_and_saveexec_b64 s[48:49], vcc
    buffer_store_short v64, v65, s[20:23], s50 offen
    s_mov_b64 exec, s[48:49]
    v_add_u32 v60, 1024, v0
    v_sub_u32 v61, 2047, v60
    v_cmp_gt_i32 vcc, 0, v61
    s_nop 1
    v_cndmask_b32 v64, v74, 0, vcc
    v_cvt_pk_bf16_f32 v64, v64, v64
    v_lshlrev_b32 v65, 1, v60
    v_cmp_gt_u32 vcc, 2096, v60
    s_and_saveexec_b64 s[48:49], vcc
    buffer_store_short v64, v65, s[20:23], s50 offen
    s_mov_b64 exec, s[48:49]
    v_add_u32 v60, 1280, v0
    v_sub_u32 v61, 2047, v60
    v_cmp_gt_i32 vcc, 0, v61
    s_nop 1
    v_cndmask_b32 v64, v75, 0, vcc
    v_cvt_pk_bf16_f32 v64, v64, v64
    v_lshlrev_b32 v65, 1, v60
    v_cmp_gt_u32 vcc, 2096, v60
    s_and_saveexec_b64 s[48:49], vcc
    buffer_store_short v64, v65, s[20:23], s50 offen
    s_mov_b64 exec, s[48:49]
    v_add_u32 v60, 1536, v0
    v_sub_u32 v61, 2047, v60
    v_cmp_gt_i32 vcc, 0, v61
    s_nop 1
    v_cndmask_b32 v64, v76, 0, vcc
    v_cvt_pk_bf16_f32 v64, v64, v64
    v_lshlrev_b32 v65, 1, v60
    v_cmp_gt_u32 vcc, 2096, v60
    s_and_saveexec_b64 s[48:49], vcc
    buffer_store_short v64, v65, s[20:23], s50 offen
    s_mov_b64 exec, s[48:49]
    v_add_u32 v60, 1792, v0
    v_sub_u32 v61, 2047, v60
    v_cmp_gt_i32 vcc, 0, v61
    s_nop 1
    v_cndmask_b32 v64, v77, 0, vcc
    v_cvt_pk_bf16_f32 v64, v64, v64
    v_lshlrev_b32 v65, 1, v60
    v_cmp_gt_u32 vcc, 2096, v60
    s_and_saveexec_b64 s[48:49], vcc
    buffer_store_short v64, v65, s[20:23], s50 offen
    s_mov_b64 exec, s[48:49]
    v_add_u32 v60, 2048, v0
    v_sub_u32 v61, 2047, v60
    v_cmp_gt_i32 vcc, 0, v61
    s_nop 1
    v_cndmask_b32 v64, v78, 0, vcc
    v_cvt_pk_bf16_f32 v64, v64, v64
    v_lshlrev_b32 v65, 1, v60
    v_cmp_gt_u32 vcc, 2096, v60
    s_and_saveexec_b64 s[48:49], vcc
    buffer_store_short v64, v65, s[20:23], s50 offen
    s_mov_b64 exec, s[48:49]
    s_endpgm
.globl k2_kernel
.p2align 8
.type k2_kernel,@function
k2_kernel:
    s_cmp_lt_u32 s2, 640
    s_cbranch_scc1 K2_GO
    s_endpgm
K2_GO:
    s_load_dwordx2 s[8:9], s[0:1], 136
    s_waitcnt lgkmcnt(0)
    s_mov_b32 s20, s8
    s_and_b32 s21, s9, 0xffff
    s_mov_b32 s22, 268435456
    s_mov_b32 s23, 0x20000
    s_mul_i32 s24, s2, 4192
    s_add_u32 s24, s24, 3145728
    s_mul_i32 s25, s2, 4224
    s_add_u32 s25, s25, 65536
    s_lshl_b32 s26, s2, 2
    v_mov_b32 v1, s26
    buffer_load_dword v2, v1, s[20:23], 0 offen
    buffer_load_dword v3, v1, s[20:23], 0 offen offset:2560
    v_mov_b32 v8, 0
    v_mov_b32 v9, 0
    v_mov_b32 v10, 0
    v_mov_b32 v11, 0
    v_lshlrev_b32 v4, 4, v0
    ds_write_b128 v4, v[8:11] offset:33280
    v_cmp_gt_u32 vcc, 128, v0
    s_and_saveexec_b64 s[28:29], vcc
    ds_write_b128 v4, v[8:11] offset:36352
    s_mov_b64 exec, s[28:29]
    v_add_u32 v5, 0, v0
    v_lshlrev_b32 v6, 4, v5
    buffer_load_dwordx4 v[16:19], v6, s[20:23], s24 offen
    buffer_load_dwordx4 v[20:23], v6, s[20:23], s24 offen offset:16
    s_waitcnt vmcnt(0)
    v_mov_b32 v24, v16
    v_mov_b32 v25, v17
    v_mov_b32 v26, v18
    v_mov_b32 v27, v19
    ds_write_b128 v6, v[24:27] offset:0
    v_alignbit_b32 v24, v17, v16, 16
    v_alignbit_b32 v25, v18, v17, 16
    v_alignbit_b32 v26, v19, v18, 16
    v_alignbit_b32 v27, v20, v19, 16
    ds_write_b128 v6, v[24:27] offset:4160
    v_mov_b32 v24, v17
    v_mov_b32 v25, v18
    v_mov_b32 v26, v19
    v_mov_b32 v27, v20
    ds_write_b128 v6, v[24:27] offset:8320
    v_alignbit_b32 v24, v18, v17, 16
    v_alignbit_b32 v25, v19, v18, 16
    v_alignbit_b32 v26, v20, v19, 16
    v_alignbit_b32 v27, v21, v20, 16
    ds_write_b128 v6, v[24:27] offset:12480
    v_mov_b32 v24, v18
    v_mov_b32 v25, v19
    v_mov_b32 v26, v20
    v_mov_b32 v27, v21
    ds_write_b128 v6, v[24:27] offset:16640
    v_alignbit_b32 v24, v19, v18, 16
    v_alignbit_b32 v25, v20, v19, 16
    v_alignbit_b32 v26, v21, v20, 16
    v_alignbit_b32 v27, v22, v21, 16
    ds_write_b128 v6, v[24:27] offset:20800
    v_mov_b32 v24, v19
    v_mov_b32 v25, v20
    v_mov_b32 v26, v21
    v_mov_b32 v27, v22
    ds_write_b128 v6, v[24:27] offset:24960
    v_alignbit_b32 v24, v20, v19, 16
    v_alignbit_b32 v25, v21, v20, 16
    v_alignbit_b32 v26, v22, v21, 16
    v_alignbit_b32 v27, v23, v22, 16
    ds_write_b128 v6, v[24:27] offset:29120
    buffer_load_dwordx4 v[16:19], v6, s[20:23], s25 offen
    v_lshlrev_b32 v7, 5, v5
    s_mov_b32 s30, 16384
    s_mov_b32 s31, 24576
    buffer_load_dwordx4 v[32:35], v7, s[20:23], s30 offen
    buffer_load_dwordx4 v[36:39], v7, s[20:23], s30 offen offset:16
    buffer_load_dwordx4 v[40:43], v7, s[20:23], s31 offen
    buffer_load_dwordx4 v[44:47], v7, s[20:23], s31 offen offset:16
    s_waitcnt vmcnt(0)
    v_add_f32 v3, 1.0, v3
    v_cvt_pk_bf16_f32 v3, v3, v3
    v_lshlrev_b32 v3, 16, v3
    v_lshlrev_b32 v48, 16, v16
    v_sub_f32 v48, v48, v32
    v_cvt_pk_bf16_f32 v48, v48, v48
    v_lshlrev_b32 v48, 16, v48
    v_rcp_f32 v49, v40
    s_nop 0
    v_mul_f32 v48, v48, v49
    v_cvt_pk_bf16_f32 v48, v48, v48
    v_lshlrev_b32 v48, 16, v48
    v_mul_f32 v48, v48, v3
    v_cvt_pk_bf16_f32 v48, v48, v48
    v_lshlrev_b32 v48, 16, v48
    v_add_f32 v48, v48, v2
    v_cvt_pk_bf16_f32 v50, v48, v48
    v_and_b32 v48, 0xffff0000, v16
    v_sub_f32 v48, v48, v33
    v_cvt_pk_bf16_f32 v48, v48, v48
    v_lshlrev_b32 v48, 16, v48
    v_rcp_f32 v49, v41
    s_nop 0
    v_mul_f32 v48, v48, v49
    v_cvt_pk_bf16_f32 v48, v48, v48
    v_lshlrev_b32 v48, 16, v48
    v_mul_f32 v48, v48, v3
    v_cvt_pk_bf16_f32 v48, v48, v48
    v_lshlrev_b32 v48, 16, v48
    v_add_f32 v48, v48, v2
    v_cvt_pk_bf16_f32 v51, v48, v48
    v_lshlrev_b32 v48, 16, v17
    v_sub_f32 v48, v48, v34
    v_cvt_pk_bf16_f32 v48, v48, v48
    v_lshlrev_b32 v48, 16, v48
    v_rcp_f32 v49, v42
    s_nop 0
    v_mul_f32 v48, v48, v49
    v_cvt_pk_bf16_f32 v48, v48, v48
    v_lshlrev_b32 v48, 16, v48
    v_mul_f32 v48, v48, v3
    v_cvt_pk_bf16_f32 v48, v48, v48
    v_lshlrev_b32 v48, 16, v48
    v_add_f32 v48, v48, v2
    v_cvt_pk_bf16_f32 v52, v48, v48
    v_and_b32 v48, 0xffff0000, v17
    v_sub_f32 v48, v48, v35
    v_cvt_pk_bf16_f32 v48, v48, v48
    v_lshlrev_b32 v48, 16, v48
    v_rcp_f32 v49, v43
    s_nop 0
    v_mul_f32 v48, v48, v49
    v_cvt_pk_bf16_f32 v48, v48, v48
    v_lshlrev_b32 v48, 16, v48
    v_mul_f32 v48, v48, v3
    v_cvt_pk_bf16_f32 v48, v48, v48
    v_lshlrev_b32 v48, 16, v48
    v_add_f32 v48, v48, v2
    v_cvt_pk_bf16_f32 v53, v48, v48
    v_lshlrev_b32 v48, 16, v18
    v_sub_f32 v48, v48, v36
    v_cvt_pk_bf16_f32 v48, v48, v48
    v_lshlrev_b32 v48, 16, v48
    v_rcp_f32 v49, v44
    s_nop 0
    v_mul_f32 v48, v48, v49
    v_cvt_pk_bf16_f32 v48, v48, v48
    v_lshlrev_b32 v48, 16, v48
    v_mul_f32 v48, v48, v3
    v_cvt_pk_bf16_f32 v48, v48, v48
    v_lshlrev_b32 v48, 16, v48
    v_add_f32 v48, v48, v2
    v_cvt_pk_bf16_f32 v54, v48, v48
    v_and_b32 v48, 0xffff0000, v18
    v_sub_f32 v48, v48, v37
    v_cvt_pk_bf16_f32 v48, v48, v48
    v_lshlrev_b32 v48, 16, v48
    v_rcp_f32 v49, v45
    s_nop 0
    v_mul_f32 v48, v48, v49
    v_cvt_pk_bf16_f32 v48, v48, v48
    v_lshlrev_b32 v48, 16, v48
    v_mul_f32 v48, v48, v3
    v_cvt_pk_bf16_f32 v48, v48, v48
    v_lshlrev_b32 v48, 16, v48
    v_add_f32 v48, v48, v2
    v_cvt_pk_bf16_f32 v55, v48, v48
    v_lshlrev_b32 v48, 16, v19
    v_sub_f32 v48, v48, v38
    v_cvt_pk_bf16_f32 v48, v48, v48
    v_lshlrev_b32 v48, 16, v48
    v_rcp_f32 v49, v46
    s_nop 0
    v_mul_f32 v48, v48, v49
    v_cvt_pk_bf16_f32 v48, v48, v48
    v_lshlrev_b32 v48, 16, v48
    v_mul_f32 v48, v48, v3
    v_cvt_pk_bf16_f32 v48, v48, v48
    v_lshlrev_b32 v48, 16, v48
    v_add_f32 v48, v48, v2
    v_cvt_pk_bf16_f32 v56, v48, v48
    v_and_b32 v48, 0xffff0000, v19
    v_sub_f32 v48, v48, v39
    v_cvt_pk_bf16_f32 v48, v48, v48
    v_lshlrev_b32 v48, 16, v48
    v_rcp_f32 v49, v47
    s_nop 0
    v_mul_f32 v48, v48, v49
    v_cvt_pk_bf16_f32 v48, v48, v48
    v_lshlrev_b32 v48, 16, v48
    v_mul_f32 v48, v48, v3
    v_cvt_pk_bf16_f32 v48, v48, v48
    v_lshlrev_b32 v48, 16, v48
    v_add_f32 v48, v48, v2
    v_cvt_pk_bf16_f32 v57, v48, v48
    v_and_b32 v50, 0xffff, v50
    v_lshl_or_b32 v24, v51, 16, v50
    v_and_b32 v52, 0xffff, v52
    v_lshl_or_b32 v25, v53, 16, v52
    v_and_b32 v54, 0xffff, v54
    v_lshl_or_b32 v26, v55, 16, v54
    v_and_b32 v56, 0xffff, v56
    v_lshl_or_b32 v27, v57, 16, v56
    v_lshrrev_b32 v7, 2, v5
    s_movk_i32 s30, 80
    v_mul_lo_u32 v7, v7, s30
    v_and_b32 v60, 3, v5
    v_lshl_add_u32 v7, v60, 4, v7
    ds_write_b128 v7, v[24:27] offset:38400
    v_add_u32 v5, 192, v0
    v_lshlrev_b32 v6, 4, v5
    v_cmp_gt_u32 vcc, 260, v5
    s_and_saveexec_b64 s[28:29], vcc
    buffer_load_dwordx4 v[16:19], v6, s[20:23], s24 offen
    buffer_load_dwordx4 v[20:23], v6, s[20:23], s24 offen offset:16
    s_waitcnt vmcnt(0)
    v_mov_b32 v24, v16
    v_mov_b32 v25, v17
    v_mov_b32 v26, v18
    v_mov_b32 v27, v19
    ds_write_b128 v6, v[24:27] offset:0
    v_alignbit_b32 v24, v17, v16, 16
    v_alignbit_b32 v25, v18, v17, 16
    v_alignbit_b32 v26, v19, v18, 16
    v_alignbit_b32 v27, v20, v19, 16
    ds_write_b128 v6, v[24:27] offset:4160
    v_mov_b32 v24, v17
    v_mov_b32 v25, v18
    v_mov_b32 v26, v19
    v_mov_b32 v27, v20
    ds_write_b128 v6, v[24:27] offset:8320
    v_alignbit_b32 v24, v18, v17, 16
    v_alignbit_b32 v25, v19, v18, 16
    v_alignbit_b32 v26, v20, v19, 16
    v_alignbit_b32 v27, v21, v20, 16
    ds_write_b128 v6, v[24:27] offset:12480
    v_mov_b32 v24, v18
    v_mov_b32 v25, v19
    v_mov_b32 v26, v20
    v_mov_b32 v27, v21
    ds_write_b128 v6, v[24:27] offset:16640
    v_alignbit_b32 v24, v19, v18, 16
    v_alignbit_b32 v25, v20, v19, 16
    v_alignbit_b32 v26, v21, v20, 16
    v_alignbit_b32 v27, v22, v21, 16
    ds_write_b128 v6, v[24:27] offset:20800
    v_mov_b32 v24, v19
    v_mov_b32 v25, v20
    v_mov_b32 v26, v21
    v_mov_b32 v27, v22
    ds_write_b128 v6, v[24:27] offset:24960
    v_alignbit_b32 v24, v20, v19, 16
    v_alignbit_b32 v25, v21, v20, 16
    v_alignbit_b32 v26, v22, v21, 16
    v_alignbit_b32 v27, v23, v22, 16
    ds_write_b128 v6, v[24:27] offset:29120
    s_mov_b64 exec, s[28:29]
    v_cmp_gt_u32 vcc, 256, v5
    s_and_saveexec_b64 s[28:29], vcc
    buffer_load_dwordx4 v[16:19], v6, s[20:23], s25 offen
    v_lshlrev_b32 v7, 5, v5
    s_mov_b32 s30, 16384
    s_mov_b32 s31, 24576
    buffer_load_dwordx4 v[32:35], v7, s[20:23], s30 offen
    buffer_load_dwordx4 v[36:39], v7, s[20:23], s30 offen offset:16
    buffer_load_dwordx4 v[40:43], v7, s[20:23], s31 offen
    buffer_load_dwordx4 v[44:47], v7, s[20:23], s31 offen offset:16
    s_waitcnt vmcnt(0)
    v_lshlrev_b32 v48, 16, v16
    v_sub_f32 v48, v48, v32
    v_cvt_pk_bf16_f32 v48, v48, v48
    v_lshlrev_b32 v48, 16, v48
    v_rcp_f32 v49, v40
    s_nop 0
    v_mul_f32 v48, v48, v49
    v_cvt_pk_bf16_f32 v48, v48, v48
    v_lshlrev_b32 v48, 16, v48
    v_mul_f32 v48, v48, v3
    v_cvt_pk_bf16_f32 v48, v48, v48
    v_lshlrev_b32 v48, 16, v48
    v_add_f32 v48, v48, v2
    v_cvt_pk_bf16_f32 v50, v48, v48
    v_and_b32 v48, 0xffff0000, v16
    v_sub_f32 v48, v48, v33
    v_cvt_pk_bf16_f32 v48, v48, v48
    v_lshlrev_b32 v48, 16, v48
    v_rcp_f32 v49, v41
    s_nop 0
    v_mul_f32 v48, v48, v49
    v_cvt_pk_bf16_f32 v48, v48, v48
    v_lshlrev_b32 v48, 16, v48
    v_mul_f32 v48, v48, v3
    v_cvt_pk_bf16_f32 v48, v48, v48
    v_lshlrev_b32 v48, 16, v48
    v_add_f32 v48, v48, v2
    v_cvt_pk_bf16_f32 v51, v48, v48
    v_lshlrev_b32 v48, 16, v17
    v_sub_f32 v48, v48, v34
    v_cvt_pk_bf16_f32 v48, v48, v48
    v_lshlrev_b32 v48, 16, v48
    v_rcp_f32 v49, v42
    s_nop 0
    v_mul_f32 v48, v48, v49
    v_cvt_pk_bf16_f32 v48, v48, v48
    v_lshlrev_b32 v48, 16, v48
    v_mul_f32 v48, v48, v3
    v_cvt_pk_bf16_f32 v48, v48, v48
    v_lshlrev_b32 v48, 16, v48
    v_add_f32 v48, v48, v2
    v_cvt_pk_bf16_f32 v52, v48, v48
    v_and_b32 v48, 0xffff0000, v17
    v_sub_f32 v48, v48, v35
    v_cvt_pk_bf16_f32 v48, v48, v48
    v_lshlrev_b32 v48, 16, v48
    v_rcp_f32 v49, v43
    s_nop 0
    v_mul_f32 v48, v48, v49
    v_cvt_pk_bf16_f32 v48, v48, v48
    v_lshlrev_b32 v48, 16, v48
    v_mul_f32 v48, v48, v3
    v_cvt_pk_bf16_f32 v48, v48, v48
    v_lshlrev_b32 v48, 16, v48
    v_add_f32 v48, v48, v2
    v_cvt_pk_bf16_f32 v53, v48, v48
    v_lshlrev_b32 v48, 16, v18
    v_sub_f32 v48, v48, v36
    v_cvt_pk_bf16_f32 v48, v48, v48
    v_lshlrev_b32 v48, 16, v48
    v_rcp_f32 v49, v44
    s_nop 0
    v_mul_f32 v48, v48, v49
    v_cvt_pk_bf16_f32 v48, v48, v48
    v_lshlrev_b32 v48, 16, v48
    v_mul_f32 v48, v48, v3
    v_cvt_pk_bf16_f32 v48, v48, v48
    v_lshlrev_b32 v48, 16, v48
    v_add_f32 v48, v48, v2
    v_cvt_pk_bf16_f32 v54, v48, v48
    v_and_b32 v48, 0xffff0000, v18
    v_sub_f32 v48, v48, v37
    v_cvt_pk_bf16_f32 v48, v48, v48
    v_lshlrev_b32 v48, 16, v48
    v_rcp_f32 v49, v45
    s_nop 0
    v_mul_f32 v48, v48, v49
    v_cvt_pk_bf16_f32 v48, v48, v48
    v_lshlrev_b32 v48, 16, v48
    v_mul_f32 v48, v48, v3
    v_cvt_pk_bf16_f32 v48, v48, v48
    v_lshlrev_b32 v48, 16, v48
    v_add_f32 v48, v48, v2
    v_cvt_pk_bf16_f32 v55, v48, v48
    v_lshlrev_b32 v48, 16, v19
    v_sub_f32 v48, v48, v38
    v_cvt_pk_bf16_f32 v48, v48, v48
    v_lshlrev_b32 v48, 16, v48
    v_rcp_f32 v49, v46
    s_nop 0
    v_mul_f32 v48, v48, v49
    v_cvt_pk_bf16_f32 v48, v48, v48
    v_lshlrev_b32 v48, 16, v48
    v_mul_f32 v48, v48, v3
    v_cvt_pk_bf16_f32 v48, v48, v48
    v_lshlrev_b32 v48, 16, v48
    v_add_f32 v48, v48, v2
    v_cvt_pk_bf16_f32 v56, v48, v48
    v_and_b32 v48, 0xffff0000, v19
    v_sub_f32 v48, v48, v39
    v_cvt_pk_bf16_f32 v48, v48, v48
    v_lshlrev_b32 v48, 16, v48
    v_rcp_f32 v49, v47
    s_nop 0
    v_mul_f32 v48, v48, v49
    v_cvt_pk_bf16_f32 v48, v48, v48
    v_lshlrev_b32 v48, 16, v48
    v_mul_f32 v48, v48, v3
    v_cvt_pk_bf16_f32 v48, v48, v48
    v_lshlrev_b32 v48, 16, v48
    v_add_f32 v48, v48, v2
    v_cvt_pk_bf16_f32 v57, v48, v48
    v_and_b32 v50, 0xffff, v50
    v_lshl_or_b32 v24, v51, 16, v50
    v_and_b32 v52, 0xffff, v52
    v_lshl_or_b32 v25, v53, 16, v52
    v_and_b32 v54, 0xffff, v54
    v_lshl_or_b32 v26, v55, 16, v54
    v_and_b32 v56, 0xffff, v56
    v_lshl_or_b32 v27, v57, 16, v56
    v_lshrrev_b32 v7, 2, v5
    s_movk_i32 s30, 80
    v_mul_lo_u32 v7, v7, s30
    v_and_b32 v60, 3, v5
    v_lshl_add_u32 v7, v60, 4, v7
    ds_write_b128 v7, v[24:27] offset:38400
    s_mov_b64 exec, s[28:29]
    s_waitcnt lgkmcnt(0)
    s_barrier
    v_lshrrev_b32 v4, 6, v0
    s_nop 1
    v_readfirstlane_b32 s32, v4
    s_nop 3
    s_cmp_eq_u32 s32, 0
    s_cselect_b32 s33, 0, 1
    s_cmp_eq_u32 s32, 2
    s_cselect_b32 s34, 32, 0
    v_and_b32 v5, 31, v0
    v_bfe_u32 v6, v0, 5, 1
    v_and_b32 v7, 7, v5
    v_sub_u32 v7, 7, v7
    s_movk_i32 s35, 4160
    v_mul_lo_u32 v7, v7, s35
    v_lshrrev_b32 v8, 3, v5
    v_lshlrev_b32 v8, 4, v8
    v_lshl_add_u32 v7, v6, 4, v7
    v_sub_u32 v7, v7, v8
    s_add_u32 s36, s34, 31
    s_lshl_b32 s36, s36, 6
    s_sub_u32 s36, 4080, s36
    v_add_u32 v7, s36, v7
    s_lshl_b32 s37, s33, 5
    s_sub_u32 s37, s37, s34
    s_sub_u32 s37, s37, 31
    v_add_u32 v8, s37, v5
    s_movk_i32 s35, 80
    v_mul_i32_i24 v8, s35, v8
    v_lshl_add_u32 v8, v6, 4, v8
    v_add_u32 v8, 38400, v8
    v_mov_b32 v64, 0
    v_mov_b32 v65, 0
    v_mov_b32 v66, 0
    v_mov_b32 v67, 0
    v_mov_b32 v68, 0
    v_mov_b32 v69, 0
    v_mov_b32 v70, 0
    v_mov_b32 v71, 0
    v_mov_b32 v72, 0
    v_mov_b32 v73, 0
    v_mov_b32 v74, 0
    v_mov_b32 v75, 0
    v_mov_b32 v76, 0
    v_mov_b32 v77, 0
    v_mov_b32 v78, 0
    v_mov_b32 v79, 0
    ds_read_b128 v[16:19], v7 offset:1984
    ds_read_b128 v[20:23], v8 offset:2480
    ds_read_b128 v[24:27], v7 offset:2016
    ds_read_b128 v[28:31], v8 offset:2512
    ds_read_b128 v[32:35], v7 offset:1920
    ds_read_b128 v[36:39], v8 offset:2400
    s_waitcnt lgkmcnt(4)
    v_mfma_f32_32x32x16_bf16 v[64:79], v[16:19], v[20:23], v[64:79]
    ds_read_b128 v[40:43], v7 offset:1952
    ds_read_b128 v[44:47], v8 offset:2432
    s_waitcnt lgkmcnt(4)
    v_mfma_f32_32x32x16_bf16 v[64:79], v[24:27], v[28:31], v[64:79]
    ds_read_b128 v[16:19], v7 offset:1856
    ds_read_b128 v[20:23], v8 offset:2320
    s_waitcnt lgkmcnt(4)
    v_mfma_f32_32x32x16_bf16 v[64:79], v[32:35], v[36:39], v[64:79]
    ds_read_b128 v[24:27], v7 offset:1888
    ds_read_b128 v[28:31], v8 offset:2352
    s_waitcnt lgkmcnt(4)
    v_mfma_f32_32x32x16_bf16 v[64:79], v[40:43], v[44:47], v[64:79]
    ds_read_b128 v[32:35], v7 offset:1792
    ds_read_b128 v[36:39], v8 offset:2240
    s_waitcnt lgkmcnt(4)
    v_mfma_f32_32x32x16_bf16 v[64:79], v[16:19], v[20:23], v[64:79]
    ds_read_b128 v[40:43], v7 offset:1824
    ds_read_b128 v[44:47], v8 offset:2272
    s_waitcnt lgkmcnt(4)
    v_mfma_f32_32x32x16_bf16 v[64:79], v[24:27], v[28:31], v[64:79]
    ds_read_b128 v[16:19], v7 offset:1728
    ds_read_b128 v[20:23], v8 offset:2160
    s_waitcnt lgkmcnt(4)
    v_mfma_f32_32x32x16_bf16 v[64:79], v[32:35], v[36:39], v[64:79]
    ds_read_b128 v[24:27], v7 offset:1760
    ds_read_b128 v[28:31], v8 offset:2192
    s_waitcnt lgkmcnt(4)
    v_mfma_f32_32x32x16_bf16 v[64:79], v[40:43], v[44:47], v[64:79]
    ds_read_b128 v[32:35], v7 offset:1664
    ds_read_b128 v[36:39], v8 offset:2080
    s_waitcnt lgkmcnt(4)
    v_mfma_f32_32x32x16_bf16 v[64:79], v[16:19], v[20:23], v[64:79]
    ds_read_b128 v[40:43], v7 offset:1696
    ds_read_b128 v[44:47], v8 offset:2112
    s_waitcnt lgkmcnt(4)
    v_mfma_f32_32x32x16_bf16 v[64:79], v[24:27], v[28:31], v[64:79]
    ds_read_b128 v[16:19], v7 offset:1600
    ds_read_b128 v[20:23], v8 offset:2000
    s_waitcnt lgkmcnt(4)
    v_mfma_f32_32x32x16_bf16 v[64:79], v[32:35], v[36:39], v[64:79]
    ds_read_b128 v[24:27], v7 offset:1632
    ds_read_b128 v[28:31], v8 offset:2032
    s_waitcnt lgkmcnt(4)
    v_mfma_f32_32x32x16_bf16 v[64:79], v[40:43], v[44:47], v[64:79]
    ds_read_b128 v[32:35], v7 offset:1536
    ds_read_b128 v[36:39], v8 offset:1920
    s_waitcnt lgkmcnt(4)
    v_mfma_f32_32x32x16_bf16 v[64:79], v[16:19], v[20:23], v[64:79]
    ds_read_b128 v[40:43], v7 offset:1568
    ds_read_b128 v[44:47], v8 offset:1952
    s_waitcnt lgkmcnt(4)
    v_mfma_f32_32x32x16_bf16 v[64:79], v[24:27], v[28:31], v[64:79]
    ds_read_b128 v[16:19], v7 offset:1472
    ds_read_b128 v[20:23], v8 offset:1840
    s_waitcnt lgkmcnt(4)
    v_mfma_f32_32x32x16_bf16 v[64:79], v[32:35], v[36:39], v[64:79]
    ds_read_b128 v[24:27], v7 offset:1504
    ds_read_b128 v[28:31], v8 offset:1872
    s_waitcnt lgkmcnt(4)
    v_mfma_f32_32x32x16_bf16 v[64:79], v[40:43], v[44:47], v[64:79]
    ds_read_b128 v[32:35], v7 offset:1408
    ds_read_b128 v[36:39], v8 offset:1760
    s_waitcnt lgkmcnt(4)
    v_mfma_f32_32x32x16_bf16 v[64:79], v[16:19], v[20:23], v[64:79]
    ds_read_b128 v[40:43], v7 offset:1440
    ds_read_b128 v[44:47], v8 offset:1792
    s_waitcnt lgkmcnt(4)
    v_mfma_f32_32x32x16_bf16 v[64:79], v[24:27], v[28:31], v[64:79]
    ds_read_b128 v[16:19], v7 offset:1344
    ds_read_b128 v[20:23], v8 offset:1680
    s_waitcnt lgkmcnt(4)
    v_mfma_f32_32x32x16_bf16 v[64:79], v[32:35], v[36:39], v[64:79]
    ds_read_b128 v[24:27], v7 offset:1376
    ds_read_b128 v[28:31], v8 offset:1712
    s_waitcnt lgkmcnt(4)
    v_mfma_f32_32x32x16_bf16 v[64:79], v[40:43], v[44:47], v[64:79]
    ds_read_b128 v[32:35], v7 offset:1280
    ds_read_b128 v[36:39], v8 offset:1600
    s_waitcnt lgkmcnt(4)
    v_mfma_f32_32x32x16_bf16 v[64:79], v[16:19], v[20:23], v[64:79]
    ds_read_b128 v[40:43], v7 offset:1312
    ds_read_b128 v[44:47], v8 offset:1632
    s_waitcnt lgkmcnt(4)
    v_mfma_f32_32x32x16_bf16 v[64:79], v[24:27], v[28:31], v[64:79]
    ds_read_b128 v[16:19], v7 offset:1216
    ds_read_b128 v[20:23], v8 offset:1520
    s_waitcnt lgkmcnt(4)
    v_mfma_f32_32x32x16_bf16 v[64:79], v[32:35], v[36:39], v[64:79]
    ds_read_b128 v[24:27], v7 offset:1248
    ds_read_b128 v[28:31], v8 offset:1552
    s_waitcnt lgkmcnt(4)
    v_mfma_f32_32x32x16_bf16 v[64:79], v[40:43], v[44:47], v[64:79]
    ds_read_b128 v[32:35], v7 offset:1152
    ds_read_b128 v[36:39], v8 offset:1440
    s_waitcnt lgkmcnt(4)
    v_mfma_f32_32x32x16_bf16 v[64:79], v[16:19], v[20:23], v[64:79]
    ds_read_b128 v[40:43], v7 offset:1184
    ds_read_b128 v[44:47], v8 offset:1472
    s_waitcnt lgkmcnt(4)
    v_mfma_f32_32x32x16_bf16 v[64:79], v[24:27], v[28:31], v[64:79]
    ds_read_b128 v[16:19], v7 offset:1088
    ds_read_b128 v[20:23], v8 offset:1360
    s_waitcnt lgkmcnt(4)
    v_mfma_f32_32x32x16_bf16 v[64:79], v[32:35], v[36:39], v[64:79]
    ds_read_b128 v[24:27], v7 offset:1120
    ds_read_b128 v[28:31], v8 offset:1392
    s_waitcnt lgkmcnt(4)
    v_mfma_f32_32x32x16_bf16 v[64:79], v[40:43], v[44:47], v[64:79]
    ds_read_b128 v[32:35], v7 offset:1024
    ds_read_b128 v[36:39], v8 offset:1280
    s_waitcnt lgkmcnt(4)
    v_mfma_f32_32x32x16_bf16 v[64:79], v[16:19], v[20:23], v[64:79]
    ds_read_b128 v[40:43], v7 offset:1056
    ds_read_b128 v[44:47], v8 offset:1312
    s_waitcnt lgkmcnt(4)
    v_mfma_f32_32x32x16_bf16 v[64:79], v[24:27], v[28:31], v[64:79]
    ds_read_b128 v[16:19], v7 offset:960
    ds_read_b128 v[20:23], v8 offset:1200
    s_waitcnt lgkmcnt(4)
    v_mfma_f32_32x32x16_bf16 v[64:79], v[32:35], v[36:39], v[64:79]
    ds_read_b128 v[24:27], v7 offset:992
    ds_read_b128 v[28:31], v8 offset:1232
    s_waitcnt lgkmcnt(4)
    v_mfma_f32_32x32x16_bf16 v[64:79], v[40:43], v[44:47], v[64:79]
    ds_read_b128 v[32:35], v7 offset:896
    ds_read_b128 v[36:39], v8 offset:1120
    s_waitcnt lgkmcnt(4)
    v_mfma_f32_32x32x16_bf16 v[64:79], v[16:19], v[20:23], v[64:79]
    ds_read_b128 v[40:43], v7 offset:928
    ds_read_b128 v[44:47], v8 offset:1152
    s_waitcnt lgkmcnt(4)
    v_mfma_f32_32x32x16_bf16 v[64:79], v[24:27], v[28:31], v[64:79]
    ds_read_b128 v[16:19], v7 offset:832
    ds_read_b128 v[20:23], v8 offset:1040
    s_waitcnt lgkmcnt(4)
    v_mfma_f32_32x32x16_bf16 v[64:79], v[32:35], v[36:39], v[64:79]
    ds_read_b128 v[24:27], v7 offset:864
    ds_read_b128 v[28:31], v8 offset:1072
    s_waitcnt lgkmcnt(4)
    v_mfma_f32_32x32x16_bf16 v[64:79], v[40:43], v[44:47], v[64:79]
    ds_read_b128 v[32:35], v7 offset:768
    ds_read_b128 v[36:39], v8 offset:960
    s_waitcnt lgkmcnt(4)
    v_mfma_f32_32x32x16_bf16 v[64:79], v[16:19], v[20:23], v[64:79]
    ds_read_b128 v[40:43], v7 offset:800
    ds_read_b128 v[44:47], v8 offset:992
    s_waitcnt lgkmcnt(4)
    v_mfma_f32_32x32x16_bf16 v[64:79], v[24:27], v[28:31], v[64:79]
    ds_read_b128 v[16:19], v7 offset:704
    ds_read_b128 v[20:23], v8 offset:880
    s_waitcnt lgkmcnt(4)
    v_mfma_f32_32x32x16_bf16 v[64:79], v[32:35], v[36:39], v[64:79]
    ds_read_b128 v[24:27], v7 offset:736
    ds_read_b128 v[28:31], v8 offset:912
    s_waitcnt lgkmcnt(4)
    v_mfma_f32_32x32x16_bf16 v[64:79], v[40:43], v[44:47], v[64:79]
    ds_read_b128 v[32:35], v7 offset:640
    ds_read_b128 v[36:39], v8 offset:800
    s_waitcnt lgkmcnt(4)
    v_mfma_f32_32x32x16_bf16 v[64:79], v[16:19], v[20:23], v[64:79]
    ds_read_b128 v[40:43], v7 offset:672
    ds_read_b128 v[44:47], v8 offset:832
    s_waitcnt lgkmcnt(4)
    v_mfma_f32_32x32x16_bf16 v[64:79], v[24:27], v[28:31], v[64:79]
    ds_read_b128 v[16:19], v7 offset:576
    ds_read_b128 v[20:23], v8 offset:720
    s_waitcnt lgkmcnt(4)
    v_mfma_f32_32x32x16_bf16 v[64:79], v[32:35], v[36:39], v[64:79]
    ds_read_b128 v[24:27], v7 offset:608
    ds_read_b128 v[28:31], v8 offset:752
    s_waitcnt lgkmcnt(4)
    v_mfma_f32_32x32x16_bf16 v[64:79], v[40:43], v[44:47], v[64:79]
    ds_read_b128 v[32:35], v7 offset:512
    ds_read_b128 v[36:39], v8 offset:640
    s_waitcnt lgkmcnt(4)
    v_mfma_f32_32x32x16_bf16 v[64:79], v[16:19], v[20:23], v[64:79]
    ds_read_b128 v[40:43], v7 offset:544
    ds_read_b128 v[44:47], v8 offset:672
    s_waitcnt lgkmcnt(4)
    v_mfma_f32_32x32x16_bf16 v[64:79], v[24:27], v[28:31], v[64:79]
    ds_read_b128 v[16:19], v7 offset:448
    ds_read_b128 v[20:23], v8 offset:560
    s_waitcnt lgkmcnt(4)
    v_mfma_f32_32x32x16_bf16 v[64:79], v[32:35], v[36:39], v[64:79]
    ds_read_b128 v[24:27], v7 offset:480
    ds_read_b128 v[28:31], v8 offset:592
    s_waitcnt lgkmcnt(4)
    v_mfma_f32_32x32x16_bf16 v[64:79], v[40:43], v[44:47], v[64:79]
    ds_read_b128 v[32:35], v7 offset:384
    ds_read_b128 v[36:39], v8 offset:480
    s_waitcnt lgkmcnt(4)
    v_mfma_f32_32x32x16_bf16 v[64:79], v[16:19], v[20:23], v[64:79]
    ds_read_b128 v[40:43], v7 offset:416
    ds_read_b128 v[44:47], v8 offset:512
    s_waitcnt lgkmcnt(4)
    v_mfma_f32_32x32x16_bf16 v[64:79], v[24:27], v[28:31], v[64:79]
    ds_read_b128 v[16:19], v7 offset:320
    ds_read_b128 v[20:23], v8 offset:400
    s_waitcnt lgkmcnt(4)
    v_mfma_f32_32x32x16_bf16 v[64:79], v[32:35], v[36:39], v[64:79]
    ds_read_b128 v[24:27], v7 offset:352
    ds_read_b128 v[28:31], v8 offset:432
    s_waitcnt lgkmcnt(4)
    v_mfma_f32_32x32x16_bf16 v[64:79], v[40:43], v[44:47], v[64:79]
    ds_read_b128 v[32:35], v7 offset:256
    ds_read_b128 v[36:39], v8 offset:320
    s_waitcnt lgkmcnt(4)
    v_mfma_f32_32x32x16_bf16 v[64:79], v[16:19], v[20:23], v[64:79]
    ds_read_b128 v[40:43], v7 offset:288
    ds_read_b128 v[44:47], v8 offset:352
    s_waitcnt lgkmcnt(4)
    v_mfma_f32_32x32x16_bf16 v[64:79], v[24:27], v[28:31], v[64:79]
    ds_read_b128 v[16:19], v7 offset:192
    ds_read_b128 v[20:23], v8 offset:240
    s_waitcnt lgkmcnt(4)
    v_mfma_f32_32x32x16_bf16 v[64:79], v[32:35], v[36:39], v[64:79]
    ds_read_b128 v[24:27], v7 offset:224
    ds_read_b128 v[28:31], v8 offset:272
    s_waitcnt lgkmcnt(4)
    v_mfma_f32_32x32x16_bf16 v[64:79], v[40:43], v[44:47], v[64:79]
    ds_read_b128 v[32:35], v7 offset:128
    ds_read_b128 v[36:39], v8 offset:160
    s_waitcnt lgkmcnt(4)
    v_mfma_f32_32x32x16_bf16 v[64:79], v[16:19], v[20:23], v[64:79]
    ds_read_b128 v[40:43], v7 offset:160
    ds_read_b128 v[44:47], v8 offset:192
    s_waitcnt lgkmcnt(4)
    v_mfma_f32_32x32x16_bf16 v[64:79], v[24:27], v[28:31], v[64:79]
    ds_read_b128 v[16:19], v7 offset:64
    ds_read_b128 v[20:23], v8 offset:80
    s_waitcnt lgkmcnt(4)
    v_mfma_f32_32x32x16_bf16 v[64:79], v[32:35], v[36:39], v[64:79]
    ds_read_b128 v[24:27], v7 offset:96
    ds_read_b128 v[28:31], v8 offset:112
    s_waitcnt lgkmcnt(4)
    v_mfma_f32_32x32x16_bf16 v[64:79], v[40:43], v[44:47], v[64:79]
    ds_read_b128 v[32:35], v7 offset:0
    ds_read_b128 v[36:39], v8 offset:0
    s_waitcnt lgkmcnt(4)
    v_mfma_f32_32x32x16_bf16 v[64:79], v[16:19], v[20:23], v[64:79]
    ds_read_b128 v[40:43], v7 offset:32
    ds_read_b128 v[44:47], v8 offset:32
    s_waitcnt lgkmcnt(4)
    v_mfma_f32_32x32x16_bf16 v[64:79], v[24:27], v[28:31], v[64:79]
    s_waitcnt lgkmcnt(2)
    v_mfma_f32_32x32x16_bf16 v[64:79], v[32:35], v[36:39], v[64:79]
    s_waitcnt lgkmcnt(0)
    v_mfma_f32_32x32x16_bf16 v[64:79], v[40:43], v[44:47], v[64:79]
    s_nop 15
    s_barrier
    v_and_b32 v9, 63, v0
    v_lshlrev_b32 v9, 2, v9
    s_cmp_eq_u32 s32, 2
    s_cbranch_scc0 K2_NW
    ds_write_b32 v9, v64 offset:0
    ds_write_b32 v9, v65 offset:256
    ds_write_b32 v9, v66 offset:512
    ds_write_b32 v9, v67 offset:768
    ds_write_b32 v9, v68 offset:1024
    ds_write_b32 v9, v69 offset:1280
    ds_write_b32 v9, v70 offset:1536
    ds_write_b32 v9, v71 offset:1792
    ds_write_b32 v9, v72 offset:2048
    ds_write_b32 v9, v73 offset:2304
    ds_write_b32 v9, v74 offset:2560
    ds_write_b32 v9, v75 offset:2816
    ds_write_b32 v9, v76 offset:3072
    ds_write_b32 v9, v77 offset:3328
    ds_write_b32 v9, v78 offset:3584
    ds_write_b32 v9, v79 offset:3840
    s_waitcnt lgkmcnt(0)
K2_NW:
    s_barrier
    s_cmp_eq_u32 s32, 2
    s_cbranch_scc1 K2_END
    s_cmp_eq_u32 s32, 1
    s_cbranch_scc0 K2_ST
    ds_read_b32 v16, v9 offset:0
    ds_read_b32 v17, v9 offset:256
    ds_read_b32 v18, v9 offset:512
    ds_read_b32 v19, v9 offset:768
    ds_read_b32 v20, v9 offset:1024
    ds_read_b32 v21, v9 offset:1280
    ds_read_b32 v22, v9 offset:1536
    ds_read_b32 v23, v9 offset:1792
    ds_read_b32 v24, v9 offset:2048
    ds_read_b32 v25, v9 offset:2304
    ds_read_b32 v26, v9 offset:2560
    ds_read_b32 v27, v9 offset:2816
    ds_read_b32 v28, v9 offset:3072
    ds_read_b32 v29, v9 offset:3328
    ds_read_b32 v30, v9 offset:3584
    ds_read_b32 v31, v9 offset:3840
    s_waitcnt lgkmcnt(0)
    v_add_f32 v64, v64, v16
    v_add_f32 v65, v65, v17
    v_add_f32 v66, v66, v18
    v_add_f32 v67, v67, v19
    v_add_f32 v68, v68, v20
    v_add_f32 v69, v69, v21
    v_add_f32 v70, v70, v22
    v_add_f32 v71, v71, v23
    v_add_f32 v72, v72, v24
    v_add_f32 v73, v73, v25
    v_add_f32 v74, v74, v26
    v_add_f32 v75, v75, v27
    v_add_f32 v76, v76, v28
    v_add_f32 v77, v77, v29
    v_add_f32 v78, v78, v30
    v_add_f32 v79, v79, v31
K2_ST:
    v_add_u32 v10, s37, v5
    s_add_u32 s38, s34, 31
    v_add_u32 v10, s38, v10
    v_lshlrev_b32 v10, 6, v10
    v_lshl_add_u32 v10, v6, 3, v10
    s_mul_i32 s39, s2, 4224
    s_add_u32 s39, s39, 6291456
    v_cvt_pk_bf16_f32 v16, v64, v65
    v_cvt_pk_bf16_f32 v17, v66, v67
    buffer_store_dwordx2 v[16:17], v10, s[20:23], s39 offen offset:0
    s_nop 1
    v_cvt_pk_bf16_f32 v16, v68, v69
    v_cvt_pk_bf16_f32 v17, v70, v71
    buffer_store_dwordx2 v[16:17], v10, s[20:23], s39 offen offset:16
    s_nop 1
    v_cvt_pk_bf16_f32 v16, v72, v73
    v_cvt_pk_bf16_f32 v17, v74, v75
    buffer_store_dwordx2 v[16:17], v10, s[20:23], s39 offen offset:32
    s_nop 1
    v_cvt_pk_bf16_f32 v16, v76, v77
    v_cvt_pk_bf16_f32 v17, v78, v79
    buffer_store_dwordx2 v[16:17], v10, s[20:23], s39 offen offset:48
    s_nop 1
K2_END:
    s_endpgm
.globl k3_kernel
.p2align 8
.type k3_kernel,@function
k3_kernel:
    s_cmp_lt_u32 s2, 512
    s_cbranch_scc1 K3_GO
    s_endpgm
K3_GO:
    s_load_dwordx2 s[4:5], s[0:1], 0
    s_load_dwordx2 s[6:7], s[0:1], 64
    s_load_dwordx2 s[8:9], s[0:1], 136
    s_waitcnt lgkmcnt(0)
    s_mov_b32 s12, s4
    s_and_b32 s13, s5, 0xffff
    s_mov_b32 s14, 2621440
    s_mov_b32 s15, 0x20000
    s_mov_b32 s16, s6
    s_and_b32 s17, s7, 0xffff
    s_mov_b32 s18, 1280
    s_mov_b32 s19, 0x20000
    s_mov_b32 s20, s8
    s_and_b32 s21, s9, 0xffff
    s_mov_b32 s22, 268435456
    s_mov_b32 s23, 0x20000
    s_lshl_b32 s24, s2, 2
    s_movk_i32 s25, 80
    v_mul_lo_u32 v11, v0, s25
    s_movk_i32 s25, 4224
    v_mul_lo_u32 v12, v0, s25
    s_lshl_b32 s27, s24, 1
    s_add_u32 s27, s27, 6291456
    v_add_u32 v12, s27, v12
    buffer_load_dwordx2 v[16:17], v12, s[20:23], 0 offen
    v_add_u32 v12, 0x108000, v12
    buffer_load_dwordx2 v[18:19], v12, s[20:23], 0 offen
    v_add_u32 v12, 0x108000, v12
    v_cmp_gt_u32 vcc, 128, v0
    s_and_saveexec_b64 s[28:29], vcc
    buffer_load_dwordx2 v[20:21], v12, s[20:23], 0 offen
    v_add_u32 v12, 0x108000, v12
    s_mov_b64 exec, s[28:29]
    v_and_b32 v1, 63, v0
    v_lshrrev_b32 v2, 6, v0
    v_lshlrev_b32 v3, 2, v1
    v_lshlrev_b32 v4, 3, v1
    s_mov_b32 s30, 0
    s_mov_b32 s31, 2560
    s_mov_b32 s32, 5120
    s_mov_b32 s33, 7680
    s_mov_b32 s34, 10240
    s_mov_b32 s35, 12800
    buffer_load_dword v40, v3, s[16:19], 0 offen offset:0
    buffer_load_dwordx2 v[50:51], v4, s[20:23], s30 offen offset:0
    buffer_load_dwordx2 v[60:61], v4, s[20:23], s31 offen offset:0
    buffer_load_dwordx2 v[70:71], v4, s[20:23], s32 offen offset:0
    buffer_load_dwordx2 v[80:81], v4, s[20:23], s33 offen offset:0
    buffer_load_dwordx2 v[90:91], v4, s[20:23], s34 offen offset:0
    buffer_load_dwordx2 v[100:101], v4, s[20:23], s35 offen offset:0
    buffer_load_dword v41, v3, s[16:19], 0 offen offset:256
    buffer_load_dwordx2 v[52:53], v4, s[20:23], s30 offen offset:512
    buffer_load_dwordx2 v[62:63], v4, s[20:23], s31 offen offset:512
    buffer_load_dwordx2 v[72:73], v4, s[20:23], s32 offen offset:512
    buffer_load_dwordx2 v[82:83], v4, s[20:23], s33 offen offset:512
    buffer_load_dwordx2 v[92:93], v4, s[20:23], s34 offen offset:512
    buffer_load_dwordx2 v[102:103], v4, s[20:23], s35 offen offset:512
    buffer_load_dword v42, v3, s[16:19], 0 offen offset:512
    buffer_load_dwordx2 v[54:55], v4, s[20:23], s30 offen offset:1024
    buffer_load_dwordx2 v[64:65], v4, s[20:23], s31 offen offset:1024
    buffer_load_dwordx2 v[74:75], v4, s[20:23], s32 offen offset:1024
    buffer_load_dwordx2 v[84:85], v4, s[20:23], s33 offen offset:1024
    buffer_load_dwordx2 v[94:95], v4, s[20:23], s34 offen offset:1024
    buffer_load_dwordx2 v[104:105], v4, s[20:23], s35 offen offset:1024
    buffer_load_dword v43, v3, s[16:19], 0 offen offset:768
    buffer_load_dwordx2 v[56:57], v4, s[20:23], s30 offen offset:1536
    buffer_load_dwordx2 v[66:67], v4, s[20:23], s31 offen offset:1536
    buffer_load_dwordx2 v[76:77], v4, s[20:23], s32 offen offset:1536
    buffer_load_dwordx2 v[86:87], v4, s[20:23], s33 offen offset:1536
    buffer_load_dwordx2 v[96:97], v4, s[20:23], s34 offen offset:1536
    buffer_load_dwordx2 v[106:107], v4, s[20:23], s35 offen offset:1536
    buffer_load_dword v44, v3, s[16:19], 0 offen offset:1024
    buffer_load_dwordx2 v[58:59], v4, s[20:23], s30 offen offset:2048
    buffer_load_dwordx2 v[68:69], v4, s[20:23], s31 offen offset:2048
    buffer_load_dwordx2 v[78:79], v4, s[20:23], s32 offen offset:2048
    buffer_load_dwordx2 v[88:89], v4, s[20:23], s33 offen offset:2048
    buffer_load_dwordx2 v[98:99], v4, s[20:23], s34 offen offset:2048
    buffer_load_dwordx2 v[108:109], v4, s[20:23], s35 offen offset:2048
    v_add_u32 v5, s24, v2
    s_movk_i32 s25, 1280
    v_mul_lo_u32 v6, v5, s25
    v_add_u32 v6, v6, v3
    v_lshlrev_b32 v7, 2, v5
    s_mov_b32 s36, 16384
    s_mov_b32 s37, 24576
    buffer_load_dword v140, v6, s[12:15], 0 offen offset:0
    buffer_load_dword v141, v6, s[12:15], 0 offen offset:256
    buffer_load_dword v142, v6, s[12:15], 0 offen offset:512
    buffer_load_dword v143, v6, s[12:15], 0 offen offset:768
    buffer_load_dword v144, v6, s[12:15], 0 offen offset:1024
    buffer_load_dword v145, v7, s[20:23], s36 offen offset:0
    buffer_load_dword v146, v7, s[20:23], s37 offen offset:0
    s_waitcnt vmcnt(0)
    ds_write_b64 v11, v[16:17]
    ds_write_b64 v11, v[18:19] offset:20480
    v_cmp_gt_u32 vcc, 128, v0
    s_and_saveexec_b64 s[28:29], vcc
    ds_write_b64 v11, v[20:21] offset:40960
    s_mov_b64 exec, s[28:29]
    s_waitcnt vmcnt(0) lgkmcnt(0)
    s_barrier
    v_add_f32 v60, 1.0, v60
    v_cvt_pk_bf16_f32 v60, v60, v60
    v_lshlrev_b32 v60, 16, v60
    v_add_f32 v61, 1.0, v61
    v_cvt_pk_bf16_f32 v61, v61, v61
    v_lshlrev_b32 v61, 16, v61
    v_add_f32 v62, 1.0, v62
    v_cvt_pk_bf16_f32 v62, v62, v62
    v_lshlrev_b32 v62, 16, v62
    v_add_f32 v63, 1.0, v63
    v_cvt_pk_bf16_f32 v63, v63, v63
    v_lshlrev_b32 v63, 16, v63
    v_add_f32 v64, 1.0, v64
    v_cvt_pk_bf16_f32 v64, v64, v64
    v_lshlrev_b32 v64, 16, v64
    v_add_f32 v65, 1.0, v65
    v_cvt_pk_bf16_f32 v65, v65, v65
    v_lshlrev_b32 v65, 16, v65
    v_add_f32 v66, 1.0, v66
    v_cvt_pk_bf16_f32 v66, v66, v66
    v_lshlrev_b32 v66, 16, v66
    v_add_f32 v67, 1.0, v67
    v_cvt_pk_bf16_f32 v67, v67, v67
    v_lshlrev_b32 v67, 16, v67
    v_add_f32 v68, 1.0, v68
    v_cvt_pk_bf16_f32 v68, v68, v68
    v_lshlrev_b32 v68, 16, v68
    v_add_f32 v69, 1.0, v69
    v_cvt_pk_bf16_f32 v69, v69, v69
    v_lshlrev_b32 v69, 16, v69
    v_add_f32 v90, 1.0, v90
    v_cvt_pk_bf16_f32 v90, v90, v90
    v_lshlrev_b32 v90, 16, v90
    v_add_f32 v91, 1.0, v91
    v_cvt_pk_bf16_f32 v91, v91, v91
    v_lshlrev_b32 v91, 16, v91
    v_add_f32 v92, 1.0, v92
    v_cvt_pk_bf16_f32 v92, v92, v92
    v_lshlrev_b32 v92, 16, v92
    v_add_f32 v93, 1.0, v93
    v_cvt_pk_bf16_f32 v93, v93, v93
    v_lshlrev_b32 v93, 16, v93
    v_add_f32 v94, 1.0, v94
    v_cvt_pk_bf16_f32 v94, v94, v94
    v_lshlrev_b32 v94, 16, v94
    v_add_f32 v95, 1.0, v95
    v_cvt_pk_bf16_f32 v95, v95, v95
    v_lshlrev_b32 v95, 16, v95
    v_add_f32 v96, 1.0, v96
    v_cvt_pk_bf16_f32 v96, v96, v96
    v_lshlrev_b32 v96, 16, v96
    v_add_f32 v97, 1.0, v97
    v_cvt_pk_bf16_f32 v97, v97, v97
    v_lshlrev_b32 v97, 16, v97
    v_add_f32 v98, 1.0, v98
    v_cvt_pk_bf16_f32 v98, v98, v98
    v_lshlrev_b32 v98, 16, v98
    v_add_f32 v99, 1.0, v99
    v_cvt_pk_bf16_f32 v99, v99, v99
    v_lshlrev_b32 v99, 16, v99
    v_add_u32 v5, s24, v2
    s_movk_i32 s25, 1280
    v_mul_lo_u32 v6, v5, s25
    v_add_u32 v6, v6, v3
    v_lshlrev_b32 v7, 2, v5
    s_movk_i32 s25, 160
    v_mul_lo_u32 v8, v1, s25
    v_lshl_add_u32 v8, v2, 1, v8
    s_mov_b32 s26, 0x3acccccd
    s_mov_b32 s36, 16384
    s_mov_b32 s37, 24576
    s_mov_b32 s38, 9437184
    s_mov_b32 s39, 12582912
    v_mov_b32 v16, v140
    v_mov_b32 v17, v141
    v_mov_b32 v18, v142
    v_mov_b32 v19, v143
    v_mov_b32 v20, v144
    v_mov_b32 v21, v145
    v_mov_b32 v22, v146
    ds_read_u16 v24, v8 offset:0
    ds_read_u16 v25, v8 offset:80
    ds_read_u16 v26, v8 offset:10240
    ds_read_u16 v27, v8 offset:10320
    ds_read_u16 v28, v8 offset:20480
    ds_read_u16 v29, v8 offset:20560
    ds_read_u16 v30, v8 offset:30720
    ds_read_u16 v31, v8 offset:30800
    ds_read_u16 v32, v8 offset:40960
    ds_read_u16 v33, v8 offset:41040
    s_waitcnt vmcnt(0) lgkmcnt(0)
    v_rcp_f32 v22, v22
    v_mov_b32 v9, 0
    v_lshlrev_b32 v110, 16, v16
    v_sub_f32 v34, v110, v21
    v_cvt_pk_bf16_f32 v34, v34, v34
    v_lshlrev_b32 v34, 16, v34
    v_mul_f32 v34, v34, v22
    v_cvt_pk_bf16_f32 v34, v34, v34
    v_lshlrev_b32 v34, 16, v34
    v_mul_f32 v34, v34, v60
    v_cvt_pk_bf16_f32 v34, v34, v34
    v_lshlrev_b32 v34, 16, v34
    v_add_f32 v34, v34, v50
    v_cvt_pk_bf16_f32 v34, v34, v34
    v_lshlrev_b32 v34, 16, v34
    v_lshlrev_b32 v35, 16, v40
    v_mul_f32 v34, v34, v35
    v_cvt_pk_bf16_f32 v34, v34, v34
    v_lshlrev_b32 v34, 16, v34
    v_lshlrev_b32 v35, 16, v24
    v_add_f32 v34, v34, v35
    v_cvt_pk_bf16_f32 v34, v34, v34
    v_lshlrev_b32 v34, 16, v34
    v_mul_f32 v34, v34, v70
    v_cvt_pk_bf16_f32 v34, v34, v34
    v_lshlrev_b32 v34, 16, v34
    v_add_f32 v110, v110, v34
    v_cvt_pk_bf16_f32 v110, v110, v110
    v_lshlrev_b32 v110, 16, v110
    v_add_f32 v9, v9, v110
    v_and_b32 v111, 0xffff0000, v16
    v_sub_f32 v34, v111, v21
    v_cvt_pk_bf16_f32 v34, v34, v34
    v_lshlrev_b32 v34, 16, v34
    v_mul_f32 v34, v34, v22
    v_cvt_pk_bf16_f32 v34, v34, v34
    v_lshlrev_b32 v34, 16, v34
    v_mul_f32 v34, v34, v61
    v_cvt_pk_bf16_f32 v34, v34, v34
    v_lshlrev_b32 v34, 16, v34
    v_add_f32 v34, v34, v51
    v_cvt_pk_bf16_f32 v34, v34, v34
    v_lshlrev_b32 v34, 16, v34
    v_and_b32 v35, 0xffff0000, v40
    v_mul_f32 v34, v34, v35
    v_cvt_pk_bf16_f32 v34, v34, v34
    v_lshlrev_b32 v34, 16, v34
    v_lshlrev_b32 v35, 16, v25
    v_add_f32 v34, v34, v35
    v_cvt_pk_bf16_f32 v34, v34, v34
    v_lshlrev_b32 v34, 16, v34
    v_mul_f32 v34, v34, v71
    v_cvt_pk_bf16_f32 v34, v34, v34
    v_lshlrev_b32 v34, 16, v34
    v_add_f32 v111, v111, v34
    v_cvt_pk_bf16_f32 v111, v111, v111
    v_lshlrev_b32 v111, 16, v111
    v_add_f32 v9, v9, v111
    v_lshlrev_b32 v112, 16, v17
    v_sub_f32 v34, v112, v21
    v_cvt_pk_bf16_f32 v34, v34, v34
    v_lshlrev_b32 v34, 16, v34
    v_mul_f32 v34, v34, v22
    v_cvt_pk_bf16_f32 v34, v34, v34
    v_lshlrev_b32 v34, 16, v34
    v_mul_f32 v34, v34, v62
    v_cvt_pk_bf16_f32 v34, v34, v34
    v_lshlrev_b32 v34, 16, v34
    v_add_f32 v34, v34, v52
    v_cvt_pk_bf16_f32 v34, v34, v34
    v_lshlrev_b32 v34, 16, v34
    v_lshlrev_b32 v35, 16, v41
    v_mul_f32 v34, v34, v35
    v_cvt_pk_bf16_f32 v34, v34, v34
    v_lshlrev_b32 v34, 16, v34
    v_lshlrev_b32 v35, 16, v26
    v_add_f32 v34, v34, v35
    v_cvt_pk_bf16_f32 v34, v34, v34
    v_lshlrev_b32 v34, 16, v34
    v_mul_f32 v34, v34, v72
    v_cvt_pk_bf16_f32 v34, v34, v34
    v_lshlrev_b32 v34, 16, v34
    v_add_f32 v112, v112, v34
    v_cvt_pk_bf16_f32 v112, v112, v112
    v_lshlrev_b32 v112, 16, v112
    v_add_f32 v9, v9, v112
    v_and_b32 v113, 0xffff0000, v17
    v_sub_f32 v34, v113, v21
    v_cvt_pk_bf16_f32 v34, v34, v34
    v_lshlrev_b32 v34, 16, v34
    v_mul_f32 v34, v34, v22
    v_cvt_pk_bf16_f32 v34, v34, v34
    v_lshlrev_b32 v34, 16, v34
    v_mul_f32 v34, v34, v63
    v_cvt_pk_bf16_f32 v34, v34, v34
    v_lshlrev_b32 v34, 16, v34
    v_add_f32 v34, v34, v53
    v_cvt_pk_bf16_f32 v34, v34, v34
    v_lshlrev_b32 v34, 16, v34
    v_and_b32 v35, 0xffff0000, v41
    v_mul_f32 v34, v34, v35
    v_cvt_pk_bf16_f32 v34, v34, v34
    v_lshlrev_b32 v34, 16, v34
    v_lshlrev_b32 v35, 16, v27
    v_add_f32 v34, v34, v35
    v_cvt_pk_bf16_f32 v34, v34, v34
    v_lshlrev_b32 v34, 16, v34
    v_mul_f32 v34, v34, v73
    v_cvt_pk_bf16_f32 v34, v34, v34
    v_lshlrev_b32 v34, 16, v34
    v_add_f32 v113, v113, v34
    v_cvt_pk_bf16_f32 v113, v113, v113
    v_lshlrev_b32 v113, 16, v113
    v_add_f32 v9, v9, v113
    v_lshlrev_b32 v114, 16, v18
    v_sub_f32 v34, v114, v21
    v_cvt_pk_bf16_f32 v34, v34, v34
    v_lshlrev_b32 v34, 16, v34
    v_mul_f32 v34, v34, v22
    v_cvt_pk_bf16_f32 v34, v34, v34
    v_lshlrev_b32 v34, 16, v34
    v_mul_f32 v34, v34, v64
    v_cvt_pk_bf16_f32 v34, v34, v34
    v_lshlrev_b32 v34, 16, v34
    v_add_f32 v34, v34, v54
    v_cvt_pk_bf16_f32 v34, v34, v34
    v_lshlrev_b32 v34, 16, v34
    v_lshlrev_b32 v35, 16, v42
    v_mul_f32 v34, v34, v35
    v_cvt_pk_bf16_f32 v34, v34, v34
    v_lshlrev_b32 v34, 16, v34
    v_lshlrev_b32 v35, 16, v28
    v_add_f32 v34, v34, v35
    v_cvt_pk_bf16_f32 v34, v34, v34
    v_lshlrev_b32 v34, 16, v34
    v_mul_f32 v34, v34, v74
    v_cvt_pk_bf16_f32 v34, v34, v34
    v_lshlrev_b32 v34, 16, v34
    v_add_f32 v114, v114, v34
    v_cvt_pk_bf16_f32 v114, v114, v114
    v_lshlrev_b32 v114, 16, v114
    v_add_f32 v9, v9, v114
    v_and_b32 v115, 0xffff0000, v18
    v_sub_f32 v34, v115, v21
    v_cvt_pk_bf16_f32 v34, v34, v34
    v_lshlrev_b32 v34, 16, v34
    v_mul_f32 v34, v34, v22
    v_cvt_pk_bf16_f32 v34, v34, v34
    v_lshlrev_b32 v34, 16, v34
    v_mul_f32 v34, v34, v65
    v_cvt_pk_bf16_f32 v34, v34, v34
    v_lshlrev_b32 v34, 16, v34
    v_add_f32 v34, v34, v55
    v_cvt_pk_bf16_f32 v34, v34, v34
    v_lshlrev_b32 v34, 16, v34
    v_and_b32 v35, 0xffff0000, v42
    v_mul_f32 v34, v34, v35
    v_cvt_pk_bf16_f32 v34, v34, v34
    v_lshlrev_b32 v34, 16, v34
    v_lshlrev_b32 v35, 16, v29
    v_add_f32 v34, v34, v35
    v_cvt_pk_bf16_f32 v34, v34, v34
    v_lshlrev_b32 v34, 16, v34
    v_mul_f32 v34, v34, v75
    v_cvt_pk_bf16_f32 v34, v34, v34
    v_lshlrev_b32 v34, 16, v34
    v_add_f32 v115, v115, v34
    v_cvt_pk_bf16_f32 v115, v115, v115
    v_lshlrev_b32 v115, 16, v115
    v_add_f32 v9, v9, v115
    v_lshlrev_b32 v116, 16, v19
    v_sub_f32 v34, v116, v21
    v_cvt_pk_bf16_f32 v34, v34, v34
    v_lshlrev_b32 v34, 16, v34
    v_mul_f32 v34, v34, v22
    v_cvt_pk_bf16_f32 v34, v34, v34
    v_lshlrev_b32 v34, 16, v34
    v_mul_f32 v34, v34, v66
    v_cvt_pk_bf16_f32 v34, v34, v34
    v_lshlrev_b32 v34, 16, v34
    v_add_f32 v34, v34, v56
    v_cvt_pk_bf16_f32 v34, v34, v34
    v_lshlrev_b32 v34, 16, v34
    v_lshlrev_b32 v35, 16, v43
    v_mul_f32 v34, v34, v35
    v_cvt_pk_bf16_f32 v34, v34, v34
    v_lshlrev_b32 v34, 16, v34
    v_lshlrev_b32 v35, 16, v30
    v_add_f32 v34, v34, v35
    v_cvt_pk_bf16_f32 v34, v34, v34
    v_lshlrev_b32 v34, 16, v34
    v_mul_f32 v34, v34, v76
    v_cvt_pk_bf16_f32 v34, v34, v34
    v_lshlrev_b32 v34, 16, v34
    v_add_f32 v116, v116, v34
    v_cvt_pk_bf16_f32 v116, v116, v116
    v_lshlrev_b32 v116, 16, v116
    v_add_f32 v9, v9, v116
    v_and_b32 v117, 0xffff0000, v19
    v_sub_f32 v34, v117, v21
    v_cvt_pk_bf16_f32 v34, v34, v34
    v_lshlrev_b32 v34, 16, v34
    v_mul_f32 v34, v34, v22
    v_cvt_pk_bf16_f32 v34, v34, v34
    v_lshlrev_b32 v34, 16, v34
    v_mul_f32 v34, v34, v67
    v_cvt_pk_bf16_f32 v34, v34, v34
    v_lshlrev_b32 v34, 16, v34
    v_add_f32 v34, v34, v57
    v_cvt_pk_bf16_f32 v34, v34, v34
    v_lshlrev_b32 v34, 16, v34
    v_and_b32 v35, 0xffff0000, v43
    v_mul_f32 v34, v34, v35
    v_cvt_pk_bf16_f32 v34, v34, v34
    v_lshlrev_b32 v34, 16, v34
    v_lshlrev_b32 v35, 16, v31
    v_add_f32 v34, v34, v35
    v_cvt_pk_bf16_f32 v34, v34, v34
    v_lshlrev_b32 v34, 16, v34
    v_mul_f32 v34, v34, v77
    v_cvt_pk_bf16_f32 v34, v34, v34
    v_lshlrev_b32 v34, 16, v34
    v_add_f32 v117, v117, v34
    v_cvt_pk_bf16_f32 v117, v117, v117
    v_lshlrev_b32 v117, 16, v117
    v_add_f32 v9, v9, v117
    v_lshlrev_b32 v118, 16, v20
    v_sub_f32 v34, v118, v21
    v_cvt_pk_bf16_f32 v34, v34, v34
    v_lshlrev_b32 v34, 16, v34
    v_mul_f32 v34, v34, v22
    v_cvt_pk_bf16_f32 v34, v34, v34
    v_lshlrev_b32 v34, 16, v34
    v_mul_f32 v34, v34, v68
    v_cvt_pk_bf16_f32 v34, v34, v34
    v_lshlrev_b32 v34, 16, v34
    v_add_f32 v34, v34, v58
    v_cvt_pk_bf16_f32 v34, v34, v34
    v_lshlrev_b32 v34, 16, v34
    v_lshlrev_b32 v35, 16, v44
    v_mul_f32 v34, v34, v35
    v_cvt_pk_bf16_f32 v34, v34, v34
    v_lshlrev_b32 v34, 16, v34
    v_lshlrev_b32 v35, 16, v32
    v_add_f32 v34, v34, v35
    v_cvt_pk_bf16_f32 v34, v34, v34
    v_lshlrev_b32 v34, 16, v34
    v_mul_f32 v34, v34, v78
    v_cvt_pk_bf16_f32 v34, v34, v34
    v_lshlrev_b32 v34, 16, v34
    v_add_f32 v118, v118, v34
    v_cvt_pk_bf16_f32 v118, v118, v118
    v_lshlrev_b32 v118, 16, v118
    v_add_f32 v9, v9, v118
    v_and_b32 v119, 0xffff0000, v20
    v_sub_f32 v34, v119, v21
    v_cvt_pk_bf16_f32 v34, v34, v34
    v_lshlrev_b32 v34, 16, v34
    v_mul_f32 v34, v34, v22
    v_cvt_pk_bf16_f32 v34, v34, v34
    v_lshlrev_b32 v34, 16, v34
    v_mul_f32 v34, v34, v69
    v_cvt_pk_bf16_f32 v34, v34, v34
    v_lshlrev_b32 v34, 16, v34
    v_add_f32 v34, v34, v59
    v_cvt_pk_bf16_f32 v34, v34, v34
    v_lshlrev_b32 v34, 16, v34
    v_and_b32 v35, 0xffff0000, v44
    v_mul_f32 v34, v34, v35
    v_cvt_pk_bf16_f32 v34, v34, v34
    v_lshlrev_b32 v34, 16, v34
    v_lshlrev_b32 v35, 16, v33
    v_add_f32 v34, v34, v35
    v_cvt_pk_bf16_f32 v34, v34, v34
    v_lshlrev_b32 v34, 16, v34
    v_mul_f32 v34, v34, v79
    v_cvt_pk_bf16_f32 v34, v34, v34
    v_lshlrev_b32 v34, 16, v34
    v_add_f32 v119, v119, v34
    v_cvt_pk_bf16_f32 v119, v119, v119
    v_lshlrev_b32 v119, 16, v119
    v_add_f32 v9, v9, v119
    v_mov_b32 v36, 0
    s_nop 1
    v_mov_b32_dpp v36, v9 row_shr:1 row_mask:0xf bank_mask:0xf
    v_add_f32 v9, v9, v36
    s_nop 1
    v_mov_b32 v36, 0
    s_nop 1
    v_mov_b32_dpp v36, v9 row_shr:2 row_mask:0xf bank_mask:0xf
    v_add_f32 v9, v9, v36
    s_nop 1
    v_mov_b32 v36, 0
    s_nop 1
    v_mov_b32_dpp v36, v9 row_shr:4 row_mask:0xf bank_mask:0xf
    v_add_f32 v9, v9, v36
    s_nop 1
    v_mov_b32 v36, 0
    s_nop 1
    v_mov_b32_dpp v36, v9 row_shr:8 row_mask:0xf bank_mask:0xf
    v_add_f32 v9, v9, v36
    s_nop 1
    v_mov_b32 v36, 0
    s_nop 1
    v_mov_b32_dpp v36, v9 row_bcast:15 row_mask:0xa bank_mask:0xf
    v_add_f32 v9, v9, v36
    s_nop 1
    v_mov_b32 v36, 0
    s_nop 1
    v_mov_b32_dpp v36, v9 row_bcast:31 row_mask:0xc bank_mask:0xf
    v_add_f32 v9, v9, v36
    s_nop 1
    v_readlane_b32 s27, v9, 63
    s_nop 3
    v_mov_b32 v37, s27
    v_mul_f32 v37, s26, v37
    v_mov_b32 v9, 0
    v_sub_f32 v34, v110, v37
    v_fmac_f32 v9, v34, v34
    v_sub_f32 v34, v111, v37
    v_fmac_f32 v9, v34, v34
    v_sub_f32 v34, v112, v37
    v_fmac_f32 v9, v34, v34
    v_sub_f32 v34, v113, v37
    v_fmac_f32 v9, v34, v34
    v_sub_f32 v34, v114, v37
    v_fmac_f32 v9, v34, v34
    v_sub_f32 v34, v115, v37
    v_fmac_f32 v9, v34, v34
    v_sub_f32 v34, v116, v37
    v_fmac_f32 v9, v34, v34
    v_sub_f32 v34, v117, v37
    v_fmac_f32 v9, v34, v34
    v_sub_f32 v34, v118, v37
    v_fmac_f32 v9, v34, v34
    v_sub_f32 v34, v119, v37
    v_fmac_f32 v9, v34, v34
    v_mov_b32 v36, 0
    s_nop 1
    v_mov_b32_dpp v36, v9 row_shr:1 row_mask:0xf bank_mask:0xf
    v_add_f32 v9, v9, v36
    s_nop 1
    v_mov_b32 v36, 0
    s_nop 1
    v_mov_b32_dpp v36, v9 row_shr:2 row_mask:0xf bank_mask:0xf
    v_add_f32 v9, v9, v36
    s_nop 1
    v_mov_b32 v36, 0
    s_nop 1
    v_mov_b32_dpp v36, v9 row_shr:4 row_mask:0xf bank_mask:0xf
    v_add_f32 v9, v9, v36
    s_nop 1
    v_mov_b32 v36, 0
    s_nop 1
    v_mov_b32_dpp v36, v9 row_shr:8 row_mask:0xf bank_mask:0xf
    v_add_f32 v9, v9, v36
    s_nop 1
    v_mov_b32 v36, 0
    s_nop 1
    v_mov_b32_dpp v36, v9 row_bcast:15 row_mask:0xa bank_mask:0xf
    v_add_f32 v9, v9, v36
    s_nop 1
    v_mov_b32 v36, 0
    s_nop 1
    v_mov_b32_dpp v36, v9 row_bcast:31 row_mask:0xc bank_mask:0xf
    v_add_f32 v9, v9, v36
    s_nop 1
    v_readlane_b32 s27, v9, 63
    s_nop 3
    v_mov_b32 v9, s27
    v_mul_f32 v9, s26, v9
    v_cvt_pk_bf16_f32 v9, v9, v9
    v_lshlrev_b32 v9, 16, v9
    v_add_f32 v9, 0x3727c5ac, v9
    v_cvt_pk_bf16_f32 v9, v9, v9
    v_lshlrev_b32 v9, 16, v9
    v_sqrt_f32 v9, v9
    s_nop 0
    v_cvt_pk_bf16_f32 v9, v9, v9
    v_lshlrev_b32 v9, 16, v9
    v_rcp_f32 v9, v9
    v_cvt_pk_bf16_f32 v37, v37, v37
    v_lshlrev_b32 v37, 16, v37
    v_sub_f32 v34, v110, v37
    v_cvt_pk_bf16_f32 v34, v34, v34
    v_lshlrev_b32 v34, 16, v34
    v_mul_f32 v34, v34, v9
    v_cvt_pk_bf16_f32 v34, v34, v34
    v_lshlrev_b32 v34, 16, v34
    v_mul_f32 v34, v34, v90
    v_cvt_pk_bf16_f32 v34, v34, v34
    v_lshlrev_b32 v34, 16, v34
    v_add_f32 v120, v34, v80
    v_sub_f32 v34, v111, v37
    v_cvt_pk_bf16_f32 v34, v34, v34
    v_lshlrev_b32 v34, 16, v34
    v_mul_f32 v34, v34, v9
    v_cvt_pk_bf16_f32 v34, v34, v34
    v_lshlrev_b32 v34, 16, v34
    v_mul_f32 v34, v34, v91
    v_cvt_pk_bf16_f32 v34, v34, v34
    v_lshlrev_b32 v34, 16, v34
    v_add_f32 v121, v34, v81
    v_sub_f32 v34, v112, v37
    v_cvt_pk_bf16_f32 v34, v34, v34
    v_lshlrev_b32 v34, 16, v34
    v_mul_f32 v34, v34, v9
    v_cvt_pk_bf16_f32 v34, v34, v34
    v_lshlrev_b32 v34, 16, v34
    v_mul_f32 v34, v34, v92
    v_cvt_pk_bf16_f32 v34, v34, v34
    v_lshlrev_b32 v34, 16, v34
    v_add_f32 v122, v34, v82
    v_sub_f32 v34, v113, v37
    v_cvt_pk_bf16_f32 v34, v34, v34
    v_lshlrev_b32 v34, 16, v34
    v_mul_f32 v34, v34, v9
    v_cvt_pk_bf16_f32 v34, v34, v34
    v_lshlrev_b32 v34, 16, v34
    v_mul_f32 v34, v34, v93
    v_cvt_pk_bf16_f32 v34, v34, v34
    v_lshlrev_b32 v34, 16, v34
    v_add_f32 v123, v34, v83
    v_sub_f32 v34, v114, v37
    v_cvt_pk_bf16_f32 v34, v34, v34
    v_lshlrev_b32 v34, 16, v34
    v_mul_f32 v34, v34, v9
    v_cvt_pk_bf16_f32 v34, v34, v34
    v_lshlrev_b32 v34, 16, v34
    v_mul_f32 v34, v34, v94
    v_cvt_pk_bf16_f32 v34, v34, v34
    v_lshlrev_b32 v34, 16, v34
    v_add_f32 v124, v34, v84
    v_sub_f32 v34, v115, v37
    v_cvt_pk_bf16_f32 v34, v34, v34
    v_lshlrev_b32 v34, 16, v34
    v_mul_f32 v34, v34, v9
    v_cvt_pk_bf16_f32 v34, v34, v34
    v_lshlrev_b32 v34, 16, v34
    v_mul_f32 v34, v34, v95
    v_cvt_pk_bf16_f32 v34, v34, v34
    v_lshlrev_b32 v34, 16, v34
    v_add_f32 v125, v34, v85
    v_sub_f32 v34, v116, v37
    v_cvt_pk_bf16_f32 v34, v34, v34
    v_lshlrev_b32 v34, 16, v34
    v_mul_f32 v34, v34, v9
    v_cvt_pk_bf16_f32 v34, v34, v34
    v_lshlrev_b32 v34, 16, v34
    v_mul_f32 v34, v34, v96
    v_cvt_pk_bf16_f32 v34, v34, v34
    v_lshlrev_b32 v34, 16, v34
    v_add_f32 v126, v34, v86
    v_sub_f32 v34, v117, v37
    v_cvt_pk_bf16_f32 v34, v34, v34
    v_lshlrev_b32 v34, 16, v34
    v_mul_f32 v34, v34, v9
    v_cvt_pk_bf16_f32 v34, v34, v34
    v_lshlrev_b32 v34, 16, v34
    v_mul_f32 v34, v34, v97
    v_cvt_pk_bf16_f32 v34, v34, v34
    v_lshlrev_b32 v34, 16, v34
    v_add_f32 v127, v34, v87
    v_sub_f32 v34, v118, v37
    v_cvt_pk_bf16_f32 v34, v34, v34
    v_lshlrev_b32 v34, 16, v34
    v_mul_f32 v34, v34, v9
    v_cvt_pk_bf16_f32 v34, v34, v34
    v_lshlrev_b32 v34, 16, v34
    v_mul_f32 v34, v34, v98
    v_cvt_pk_bf16_f32 v34, v34, v34
    v_lshlrev_b32 v34, 16, v34
    v_add_f32 v128, v34, v88
    v_sub_f32 v34, v119, v37
    v_cvt_pk_bf16_f32 v34, v34, v34
    v_lshlrev_b32 v34, 16, v34
    v_mul_f32 v34, v34, v9
    v_cvt_pk_bf16_f32 v34, v34, v34
    v_lshlrev_b32 v34, 16, v34
    v_mul_f32 v34, v34, v99
    v_cvt_pk_bf16_f32 v34, v34, v34
    v_lshlrev_b32 v34, 16, v34
    v_add_f32 v129, v34, v89
    v_cvt_pk_bf16_f32 v34, v110, v111
    v_cvt_pk_bf16_f32 v35, v120, v121
    buffer_store_dword v34, v6, s[20:23], s38 offen offset:0
    buffer_store_dword v35, v6, s[20:23], s39 offen offset:0
    v_cvt_pk_bf16_f32 v34, v112, v113
    v_cvt_pk_bf16_f32 v35, v122, v123
    buffer_store_dword v34, v6, s[20:23], s38 offen offset:256
    buffer_store_dword v35, v6, s[20:23], s39 offen offset:256
    v_cvt_pk_bf16_f32 v34, v114, v115
    v_cvt_pk_bf16_f32 v35, v124, v125
    buffer_store_dword v34, v6, s[20:23], s38 offen offset:512
    buffer_store_dword v35, v6, s[20:23], s39 offen offset:512
    v_cvt_pk_bf16_f32 v34, v116, v117
    v_cvt_pk_bf16_f32 v35, v126, v127
    buffer_store_dword v34, v6, s[20:23], s38 offen offset:768
    buffer_store_dword v35, v6, s[20:23], s39 offen offset:768
    v_cvt_pk_bf16_f32 v34, v118, v119
    v_cvt_pk_bf16_f32 v35, v128, v129
    buffer_store_dword v34, v6, s[20:23], s38 offen offset:1024
    buffer_store_dword v35, v6, s[20:23], s39 offen offset:1024
    v_add_u32 v6, 1280, v6
    s_endpgm
.globl k4_kernel
.p2align 8
.type k4_kernel,@function
k4_kernel:
    s_cmp_lt_u32 s2, 432
    s_cbranch_scc1 G1_GO
    s_endpgm
G1_GO:
    s_load_dwordx2 s[4:5], s[0:1], 80
    s_load_dwordx2 s[6:7], s[0:1], 88
    s_load_dwordx2 s[10:11], s[0:1], 96
    s_load_dwordx2 s[8:9], s[0:1], 136
    s_load_dwordx2 s[36:37], s[0:1], 120
    s_waitcnt lgkmcnt(0)
    s_mov_b32 s20, s8
    s_and_b32 s21, s9, 0xffff
    s_mov_b32 s22, 268435456
    s_mov_b32 s23, 0x20000
    s_mov_b32 s12, s4
    s_and_b32 s13, s5, 0xffff
    s_mov_b32 s14, 2211840
    s_mov_b32 s15, 0x20000
    s_mov_b32 s16, s6
    s_and_b32 s17, s7, 0xffff
    s_mov_b32 s18, 2211840
    s_mov_b32 s19, 0x20000
    s_mov_b32 s24, 159072863
    s_lshr_b32 s38, s2, 3
    s_mul_hi_u32 s25, s38, s24
    s_mul_i32 s26, s25, 27
    s_sub_u32 s26, s38, s26
    s_and_b32 s39, s2, 7
    s_lshl_b32 s25, s25, 3
    s_add_u32 s25, s25, s39
    v_lshrrev_b32 v1, 3, v0
    v_and_b32 v2, 7, v0
    s_mul_i32 s27, s25, 128
    v_add_u32 v3, s27, v1
    s_movk_i32 s28, 1280
    v_mul_lo_u32 v3, v3, s28
    v_lshl_add_u32 v3, v2, 4, v3
    s_movk_i32 s28, 272
    v_mul_lo_u32 v4, v1, s28
    v_lshl_add_u32 v4, v2, 4, v4
    s_mov_b32 s29, 12582912
    s_movk_i32 s28, 3456
    v_mul_lo_u32 v5, v1, s28
    v_lshl_add_u32 v5, v2, 4, v5
    s_mul_i32 s30, s26, 128
    s_add_u32 s31, s30, 0
    s_movk_i32 s28, 320
    v_mul_lo_u32 v6, v1, s28
    v_lshl_add_u32 v6, v2, 4, v6
    v_lshrrev_b32 v7, 6, v0
    v_and_b32 v8, 63, v0
    v_lshrrev_b32 v9, 1, v7
    v_and_b32 v10, 1, v7
    v_and_b32 v11, 31, v8
    v_lshrrev_b32 v12, 5, v8
    v_mul_u32_u24 v13, 64, v9
    v_add_u32 v13, v13, v11
    s_movk_i32 s28, 272
    v_mul_lo_u32 v13, v13, s28
    v_lshl_add_u32 v13, v12, 4, v13
    v_lshrrev_b32 v14, 4, v8
    v_lshrrev_b32 v15, 1, v14
    v_lshlrev_b32 v15, 3, v15
    v_bfe_u32 v16, v8, 2, 2
    v_add_u32 v15, v15, v16
    s_movk_i32 s28, 320
    v_mul_lo_u32 v15, v15, s28
    v_and_b32 v16, 1, v14
    v_lshlrev_b32 v16, 5, v16
    v_lshl_add_u32 v16, v10, 6, v16
    v_and_b32 v17, 3, v8
    v_lshl_add_u32 v16, v17, 3, v16
    v_add_u32 v15, v15, v16
    v_add_u32 v15, 34816, v15
    v_mov_b32 v64, 0
    v_mov_b32 v65, 0
    v_mov_b32 v66, 0
    v_mov_b32 v67, 0
    v_mov_b32 v68, 0
    v_mov_b32 v69, 0
    v_mov_b32 v70, 0
    v_mov_b32 v71, 0
    v_mov_b32 v72, 0
    v_mov_b32 v73, 0
    v_mov_b32 v74, 0
    v_mov_b32 v75, 0
    v_mov_b32 v76, 0
    v_mov_b32 v77, 0
    v_mov_b32 v78, 0
    v_mov_b32 v79, 0
    v_mov_b32 v80, 0
    v_mov_b32 v81, 0
    v_mov_b32 v82, 0
    v_mov_b32 v83, 0
    v_mov_b32 v84, 0
    v_mov_b32 v85, 0
    v_mov_b32 v86, 0
    v_mov_b32 v87, 0
    v_mov_b32 v88, 0
    v_mov_b32 v89, 0
    v_mov_b32 v90, 0
    v_mov_b32 v91, 0
    v_mov_b32 v92, 0
    v_mov_b32 v93, 0
    v_mov_b32 v94, 0
    v_mov_b32 v95, 0
    v_mov_b32 v96, 0
    v_mov_b32 v97, 0
    v_mov_b32 v98, 0
    v_mov_b32 v99, 0
    v_mov_b32 v100, 0
    v_mov_b32 v101, 0
    v_mov_b32 v102, 0
    v_mov_b32 v103, 0
    v_mov_b32 v104, 0
    v_mov_b32 v105, 0
    v_mov_b32 v106, 0
    v_mov_b32 v107, 0
    v_mov_b32 v108, 0
    v_mov_b32 v109, 0
    v_mov_b32 v110, 0
    v_mov_b32 v111, 0
    v_mov_b32 v112, 0
    v_mov_b32 v113, 0
    v_mov_b32 v114, 0
    v_mov_b32 v115, 0
    v_mov_b32 v116, 0
    v_mov_b32 v117, 0
    v_mov_b32 v118, 0
    v_mov_b32 v119, 0
    v_mov_b32 v120, 0
    v_mov_b32 v121, 0
    v_mov_b32 v122, 0
    v_mov_b32 v123, 0
    v_mov_b32 v124, 0
    v_mov_b32 v125, 0
    v_mov_b32 v126, 0
    v_mov_b32 v127, 0
    v_add_u32 v18, 0, v3
    buffer_load_dwordx4 v[144:147], v18, s[20:23], s29 offen
    v_add_u32 v18, 128, v3
    buffer_load_dwordx4 v[148:151], v18, s[20:23], s29 offen
    v_add_u32 v18, 40960, v3
    buffer_load_dwordx4 v[152:155], v18, s[20:23], s29 offen
    v_add_u32 v18, 41088, v3
    buffer_load_dwordx4 v[156:159], v18, s[20:23], s29 offen
    v_add_u32 v18, 81920, v3
    buffer_load_dwordx4 v[160:163], v18, s[20:23], s29 offen
    v_add_u32 v18, 82048, v3
    buffer_load_dwordx4 v[164:167], v18, s[20:23], s29 offen
    v_add_u32 v18, 122880, v3
    buffer_load_dwordx4 v[168:171], v18, s[20:23], s29 offen
    v_add_u32 v18, 123008, v3
    buffer_load_dwordx4 v[172:175], v18, s[20:23], s29 offen
    v_add_u32 v18, 0, v5
    buffer_load_dwordx4 v[176:179], v18, s[12:15], s30 offen
    buffer_load_dwordx4 v[180:183], v18, s[16:19], s31 offen
    v_add_u32 v18, 110592, v5
    buffer_load_dwordx4 v[184:187], v18, s[12:15], s30 offen
    buffer_load_dwordx4 v[188:191], v18, s[16:19], s31 offen
    v_add_u32 v18, 221184, v5
    buffer_load_dwordx4 v[192:195], v18, s[12:15], s30 offen
    buffer_load_dwordx4 v[196:199], v18, s[16:19], s31 offen
    v_add_u32 v18, 331776, v5
    buffer_load_dwordx4 v[200:203], v18, s[12:15], s30 offen
    buffer_load_dwordx4 v[204:207], v18, s[16:19], s31 offen
    s_waitcnt vmcnt(0)
    ds_write_b128 v4, v[144:147] offset:0
    ds_write_b128 v4, v[148:151] offset:128
    ds_write_b128 v4, v[152:155] offset:8704
    ds_write_b128 v4, v[156:159] offset:8832
    ds_write_b128 v4, v[160:163] offset:17408
    ds_write_b128 v4, v[164:167] offset:17536
    ds_write_b128 v4, v[168:171] offset:26112
    ds_write_b128 v4, v[172:175] offset:26240
    v_add_u32 v18, 34816, v6
    ds_write_b128 v18, v[176:179]
    ds_write_b128 v18, v[180:183] offset:128
    v_add_u32 v18, 45056, v6
    ds_write_b128 v18, v[184:187]
    ds_write_b128 v18, v[188:191] offset:128
    v_add_u32 v18, 55296, v6
    ds_write_b128 v18, v[192:195]
    ds_write_b128 v18, v[196:199] offset:128
    v_add_u32 v18, 65536, v6
    ds_write_b128 v18, v[200:203]
    ds_write_b128 v18, v[204:207] offset:128
    s_waitcnt lgkmcnt(0)
    s_barrier
    v_add_u32 v3, 256, v3
    v_add_u32 v5, 442368, v5
    v_add_u32 v18, 0, v3
    buffer_load_dwordx4 v[144:147], v18, s[20:23], s29 offen
    v_add_u32 v18, 128, v3
    buffer_load_dwordx4 v[148:151], v18, s[20:23], s29 offen
    v_add_u32 v18, 40960, v3
    buffer_load_dwordx4 v[152:155], v18, s[20:23], s29 offen
    v_add_u32 v18, 41088, v3
    buffer_load_dwordx4 v[156:159], v18, s[20:23], s29 offen
    v_add_u32 v18, 81920, v3
    buffer_load_dwordx4 v[160:163], v18, s[20:23], s29 offen
    v_add_u32 v18, 82048, v3
    buffer_load_dwordx4 v[164:167], v18, s[20:23], s29 offen
    v_add_u32 v18, 122880, v3
    buffer_load_dwordx4 v[168:171], v18, s[20:23], s29 offen
    v_add_u32 v18, 123008, v3
    buffer_load_dwordx4 v[172:175], v18, s[20:23], s29 offen
    v_add_u32 v18, 0, v5
    buffer_load_dwordx4 v[176:179], v18, s[12:15], s30 offen
    buffer_load_dwordx4 v[180:183], v18, s[16:19], s31 offen
    v_add_u32 v18, 110592, v5
    buffer_load_dwordx4 v[184:187], v18, s[12:15], s30 offen
    buffer_load_dwordx4 v[188:191], v18, s[16:19], s31 offen
    v_add_u32 v18, 221184, v5
    buffer_load_dwordx4 v[192:195], v18, s[12:15], s30 offen
    buffer_load_dwordx4 v[196:199], v18, s[16:19], s31 offen
    v_add_u32 v18, 331776, v5
    buffer_load_dwordx4 v[200:203], v18, s[12:15], s30 offen
    buffer_load_dwordx4 v[204:207], v18, s[16:19], s31 offen
    ds_read_b128 v[128:131], v13 offset:0
    ds_read_b128 v[132:135], v13 offset:8704
    ds_read_b64_tr_b16 v[136:137], v15 offset:0
    ds_read_b64_tr_b16 v[138:139], v15 offset:1280
    ds_read_b64_tr_b16 v[140:141], v15 offset:128
    ds_read_b64_tr_b16 v[142:143], v15 offset:1408
    ds_read_b128 v[240:243], v13 offset:32
    ds_read_b128 v[244:247], v13 offset:8736
    ds_read_b64_tr_b16 v[248:249], v15 offset:5120
    ds_read_b64_tr_b16 v[250:251], v15 offset:6400
    ds_read_b64_tr_b16 v[252:253], v15 offset:5248
    ds_read_b64_tr_b16 v[254:255], v15 offset:6528
    s_waitcnt lgkmcnt(6)
    v_mfma_f32_32x32x16_bf16 v[64:79], v[128:131], v[136:139], v[64:79]
    v_mfma_f32_32x32x16_bf16 v[80:95], v[128:131], v[140:143], v[80:95]
    v_mfma_f32_32x32x16_bf16 v[96:111], v[132:135], v[136:139], v[96:111]
    v_mfma_f32_32x32x16_bf16 v[112:127], v[132:135], v[140:143], v[112:127]
    ds_read_b128 v[128:131], v13 offset:64
    ds_read_b128 v[132:135], v13 offset:8768
    ds_read_b64_tr_b16 v[136:137], v15 offset:10240
    ds_read_b64_tr_b16 v[138:139], v15 offset:11520
    ds_read_b64_tr_b16 v[140:141], v15 offset:10368
    ds_read_b64_tr_b16 v[142:143], v15 offset:11648
    s_waitcnt lgkmcnt(6)
    v_mfma_f32_32x32x16_bf16 v[64:79], v[240:243], v[248:251], v[64:79]
    v_mfma_f32_32x32x16_bf16 v[80:95], v[240:243], v[252:255], v[80:95]
    v_mfma_f32_32x32x16_bf16 v[96:111], v[244:247], v[248:251], v[96:111]
    v_mfma_f32_32x32x16_bf16 v[112:127], v[244:247], v[252:255], v[112:127]
    ds_read_b128 v[240:243], v13 offset:96
    ds_read_b128 v[244:247], v13 offset:8800
    ds_read_b64_tr_b16 v[248:249], v15 offset:15360
    ds_read_b64_tr_b16 v[250:251], v15 offset:16640
    ds_read_b64_tr_b16 v[252:253], v15 offset:15488
    ds_read_b64_tr_b16 v[254:255], v15 offset:16768
    s_waitcnt lgkmcnt(6)
    v_mfma_f32_32x32x16_bf16 v[64:79], v[128:131], v[136:139], v[64:79]
    v_mfma_f32_32x32x16_bf16 v[80:95], v[128:131], v[140:143], v[80:95]
    v_mfma_f32_32x32x16_bf16 v[96:111], v[132:135], v[136:139], v[96:111]
    v_mfma_f32_32x32x16_bf16 v[112:127], v[132:135], v[140:143], v[112:127]
    ds_read_b128 v[128:131], v13 offset:128
    ds_read_b128 v[132:135], v13 offset:8832
    ds_read_b64_tr_b16 v[136:137], v15 offset:20480
    ds_read_b64_tr_b16 v[138:139], v15 offset:21760
    ds_read_b64_tr_b16 v[140:141], v15 offset:20608
    ds_read_b64_tr_b16 v[142:143], v15 offset:21888
    s_waitcnt lgkmcnt(6)
    v_mfma_f32_32x32x16_bf16 v[64:79], v[240:243], v[248:251], v[64:79]
    v_mfma_f32_32x32x16_bf16 v[80:95], v[240:243], v[252:255], v[80:95]
    v_mfma_f32_32x32x16_bf16 v[96:111], v[244:247], v[248:251], v[96:111]
    v_mfma_f32_32x32x16_bf16 v[112:127], v[244:247], v[252:255], v[112:127]
    ds_read_b128 v[240:243], v13 offset:160
    ds_read_b128 v[244:247], v13 offset:8864
    ds_read_b64_tr_b16 v[248:249], v15 offset:25600
    ds_read_b64_tr_b16 v[250:251], v15 offset:26880
    ds_read_b64_tr_b16 v[252:253], v15 offset:25728
    ds_read_b64_tr_b16 v[254:255], v15 offset:27008
    s_waitcnt lgkmcnt(6)
    v_mfma_f32_32x32x16_bf16 v[64:79], v[128:131], v[136:139], v[64:79]
    v_mfma_f32_32x32x16_bf16 v[80:95], v[128:131], v[140:143], v[80:95]
    v_mfma_f32_32x32x16_bf16 v[96:111], v[132:135], v[136:139], v[96:111]
    v_mfma_f32_32x32x16_bf16 v[112:127], v[132:135], v[140:143], v[112:127]
    ds_read_b128 v[128:131], v13 offset:192
    ds_read_b128 v[132:135], v13 offset:8896
    ds_read_b64_tr_b16 v[136:137], v15 offset:30720
    ds_read_b64_tr_b16 v[138:139], v15 offset:32000
    ds_read_b64_tr_b16 v[140:141], v15 offset:30848
    ds_read_b64_tr_b16 v[142:143], v15 offset:32128
    s_waitcnt lgkmcnt(6)
    v_mfma_f32_32x32x16_bf16 v[64:79], v[240:243], v[248:251], v[64:79]
    v_mfma_f32_32x32x16_bf16 v[80:95], v[240:243], v[252:255], v[80:95]
    v_mfma_f32_32x32x16_bf16 v[96:111], v[244:247], v[248:251], v[96:111]
    v_mfma_f32_32x32x16_bf16 v[112:127], v[244:247], v[252:255], v[112:127]
    ds_read_b128 v[240:243], v13 offset:224
    ds_read_b128 v[244:247], v13 offset:8928
    ds_read_b64_tr_b16 v[248:249], v15 offset:35840
    ds_read_b64_tr_b16 v[250:251], v15 offset:37120
    ds_read_b64_tr_b16 v[252:253], v15 offset:35968
    ds_read_b64_tr_b16 v[254:255], v15 offset:37248
    s_waitcnt lgkmcnt(6)
    v_mfma_f32_32x32x16_bf16 v[64:79], v[128:131], v[136:139], v[64:79]
    v_mfma_f32_32x32x16_bf16 v[80:95], v[128:131], v[140:143], v[80:95]
    v_mfma_f32_32x32x16_bf16 v[96:111], v[132:135], v[136:139], v[96:111]
    v_mfma_f32_32x32x16_bf16 v[112:127], v[132:135], v[140:143], v[112:127]
    s_waitcnt lgkmcnt(0)
    v_mfma_f32_32x32x16_bf16 v[64:79], v[240:243], v[248:251], v[64:79]
    v_mfma_f32_32x32x16_bf16 v[80:95], v[240:243], v[252:255], v[80:95]
    v_mfma_f32_32x32x16_bf16 v[96:111], v[244:247], v[248:251], v[96:111]
    v_mfma_f32_32x32x16_bf16 v[112:127], v[244:247], v[252:255], v[112:127]
    s_barrier
    s_waitcnt vmcnt(0)
    ds_write_b128 v4, v[144:147] offset:0
    ds_write_b128 v4, v[148:151] offset:128
    ds_write_b128 v4, v[152:155] offset:8704
    ds_write_b128 v4, v[156:159] offset:8832
    ds_write_b128 v4, v[160:163] offset:17408
    ds_write_b128 v4, v[164:167] offset:17536
    ds_write_b128 v4, v[168:171] offset:26112
    ds_write_b128 v4, v[172:175] offset:26240
    v_add_u32 v18, 34816, v6
    ds_write_b128 v18, v[176:179]
    ds_write_b128 v18, v[180:183] offset:128
    v_add_u32 v18, 45056, v6
    ds_write_b128 v18, v[184:187]
    ds_write_b128 v18, v[188:191] offset:128
    v_add_u32 v18, 55296, v6
    ds_write_b128 v18, v[192:195]
    ds_write_b128 v18, v[196:199] offset:128
    v_add_u32 v18, 65536, v6
    ds_write_b128 v18, v[200:203]
    ds_write_b128 v18, v[204:207] offset:128
    s_waitcnt lgkmcnt(0)
    s_barrier
    v_add_u32 v3, 256, v3
    v_add_u32 v5, 442368, v5
    v_add_u32 v18, 0, v3
    buffer_load_dwordx4 v[144:147], v18, s[20:23], s29 offen
    v_add_u32 v18, 128, v3
    buffer_load_dwordx4 v[148:151], v18, s[20:23], s29 offen
    v_add_u32 v18, 40960, v3
    buffer_load_dwordx4 v[152:155], v18, s[20:23], s29 offen
    v_add_u32 v18, 41088, v3
    buffer_load_dwordx4 v[156:159], v18, s[20:23], s29 offen
    v_add_u32 v18, 81920, v3
    buffer_load_dwordx4 v[160:163], v18, s[20:23], s29 offen
    v_add_u32 v18, 82048, v3
    buffer_load_dwordx4 v[164:167], v18, s[20:23], s29 offen
    v_add_u32 v18, 122880, v3
    buffer_load_dwordx4 v[168:171], v18, s[20:23], s29 offen
    v_add_u32 v18, 123008, v3
    buffer_load_dwordx4 v[172:175], v18, s[20:23], s29 offen
    v_add_u32 v18, 0, v5
    buffer_load_dwordx4 v[176:179], v18, s[12:15], s30 offen
    buffer_load_dwordx4 v[180:183], v18, s[16:19], s31 offen
    v_add_u32 v18, 110592, v5
    buffer_load_dwordx4 v[184:187], v18, s[12:15], s30 offen
    buffer_load_dwordx4 v[188:191], v18, s[16:19], s31 offen
    v_add_u32 v18, 221184, v5
    buffer_load_dwordx4 v[192:195], v18, s[12:15], s30 offen
    buffer_load_dwordx4 v[196:199], v18, s[16:19], s31 offen
    v_add_u32 v18, 331776, v5
    buffer_load_dwordx4 v[200:203], v18, s[12:15], s30 offen
    buffer_load_dwordx4 v[204:207], v18, s[16:19], s31 offen
    ds_read_b128 v[128:131], v13 offset:0
    ds_read_b128 v[132:135], v13 offset:8704
    ds_read_b64_tr_b16 v[136:137], v15 offset:0
    ds_read_b64_tr_b16 v[138:139], v15 offset:1280
    ds_read_b64_tr_b16 v[140:141], v15 offset:128
    ds_read_b64_tr_b16 v[142:143], v15 offset:1408
    ds_read_b128 v[240:243], v13 offset:32
    ds_read_b128 v[244:247], v13 offset:8736
    ds_read_b64_tr_b16 v[248:249], v15 offset:5120
    ds_read_b64_tr_b16 v[250:251], v15 offset:6400
    ds_read_b64_tr_b16 v[252:253], v15 offset:5248
    ds_read_b64_tr_b16 v[254:255], v15 offset:6528
    s_waitcnt lgkmcnt(6)
    v_mfma_f32_32x32x16_bf16 v[64:79], v[128:131], v[136:139], v[64:79]
    v_mfma_f32_32x32x16_bf16 v[80:95], v[128:131], v[140:143], v[80:95]
    v_mfma_f32_32x32x16_bf16 v[96:111], v[132:135], v[136:139], v[96:111]
    v_mfma_f32_32x32x16_bf16 v[112:127], v[132:135], v[140:143], v[112:127]
    ds_read_b128 v[128:131], v13 offset:64
    ds_read_b128 v[132:135], v13 offset:8768
    ds_read_b64_tr_b16 v[136:137], v15 offset:10240
    ds_read_b64_tr_b16 v[138:139], v15 offset:11520
    ds_read_b64_tr_b16 v[140:141], v15 offset:10368
    ds_read_b64_tr_b16 v[142:143], v15 offset:11648
    s_waitcnt lgkmcnt(6)
    v_mfma_f32_32x32x16_bf16 v[64:79], v[240:243], v[248:251], v[64:79]
    v_mfma_f32_32x32x16_bf16 v[80:95], v[240:243], v[252:255], v[80:95]
    v_mfma_f32_32x32x16_bf16 v[96:111], v[244:247], v[248:251], v[96:111]
    v_mfma_f32_32x32x16_bf16 v[112:127], v[244:247], v[252:255], v[112:127]
    ds_read_b128 v[240:243], v13 offset:96
    ds_read_b128 v[244:247], v13 offset:8800
    ds_read_b64_tr_b16 v[248:249], v15 offset:15360
    ds_read_b64_tr_b16 v[250:251], v15 offset:16640
    ds_read_b64_tr_b16 v[252:253], v15 offset:15488
    ds_read_b64_tr_b16 v[254:255], v15 offset:16768
    s_waitcnt lgkmcnt(6)
    v_mfma_f32_32x32x16_bf16 v[64:79], v[128:131], v[136:139], v[64:79]
    v_mfma_f32_32x32x16_bf16 v[80:95], v[128:131], v[140:143], v[80:95]
    v_mfma_f32_32x32x16_bf16 v[96:111], v[132:135], v[136:139], v[96:111]
    v_mfma_f32_32x32x16_bf16 v[112:127], v[132:135], v[140:143], v[112:127]
    ds_read_b128 v[128:131], v13 offset:128
    ds_read_b128 v[132:135], v13 offset:8832
    ds_read_b64_tr_b16 v[136:137], v15 offset:20480
    ds_read_b64_tr_b16 v[138:139], v15 offset:21760
    ds_read_b64_tr_b16 v[140:141], v15 offset:20608
    ds_read_b64_tr_b16 v[142:143], v15 offset:21888
    s_waitcnt lgkmcnt(6)
    v_mfma_f32_32x32x16_bf16 v[64:79], v[240:243], v[248:251], v[64:79]
    v_mfma_f32_32x32x16_bf16 v[80:95], v[240:243], v[252:255], v[80:95]
    v_mfma_f32_32x32x16_bf16 v[96:111], v[244:247], v[248:251], v[96:111]
    v_mfma_f32_32x32x16_bf16 v[112:127], v[244:247], v[252:255], v[112:127]
    ds_read_b128 v[240:243], v13 offset:160
    ds_read_b128 v[244:247], v13 offset:8864
    ds_read_b64_tr_b16 v[248:249], v15 offset:25600
    ds_read_b64_tr_b16 v[250:251], v15 offset:26880
    ds_read_b64_tr_b16 v[252:253], v15 offset:25728
    ds_read_b64_tr_b16 v[254:255], v15 offset:27008
    s_waitcnt lgkmcnt(6)
    v_mfma_f32_32x32x16_bf16 v[64:79], v[128:131], v[136:139], v[64:79]
    v_mfma_f32_32x32x16_bf16 v[80:95], v[128:131], v[140:143], v[80:95]
    v_mfma_f32_32x32x16_bf16 v[96:111], v[132:135], v[136:139], v[96:111]
    v_mfma_f32_32x32x16_bf16 v[112:127], v[132:135], v[140:143], v[112:127]
    ds_read_b128 v[128:131], v13 offset:192
    ds_read_b128 v[132:135], v13 offset:8896
    ds_read_b64_tr_b16 v[136:137], v15 offset:30720
    ds_read_b64_tr_b16 v[138:139], v15 offset:32000
    ds_read_b64_tr_b16 v[140:141], v15 offset:30848
    ds_read_b64_tr_b16 v[142:143], v15 offset:32128
    s_waitcnt lgkmcnt(6)
    v_mfma_f32_32x32x16_bf16 v[64:79], v[240:243], v[248:251], v[64:79]
    v_mfma_f32_32x32x16_bf16 v[80:95], v[240:243], v[252:255], v[80:95]
    v_mfma_f32_32x32x16_bf16 v[96:111], v[244:247], v[248:251], v[96:111]
    v_mfma_f32_32x32x16_bf16 v[112:127], v[244:247], v[252:255], v[112:127]
    ds_read_b128 v[240:243], v13 offset:224
    ds_read_b128 v[244:247], v13 offset:8928
    ds_read_b64_tr_b16 v[248:249], v15 offset:35840
    ds_read_b64_tr_b16 v[250:251], v15 offset:37120
    ds_read_b64_tr_b16 v[252:253], v15 offset:35968
    ds_read_b64_tr_b16 v[254:255], v15 offset:37248
    s_waitcnt lgkmcnt(6)
    v_mfma_f32_32x32x16_bf16 v[64:79], v[128:131], v[136:139], v[64:79]
    v_mfma_f32_32x32x16_bf16 v[80:95], v[128:131], v[140:143], v[80:95]
    v_mfma_f32_32x32x16_bf16 v[96:111], v[132:135], v[136:139], v[96:111]
    v_mfma_f32_32x32x16_bf16 v[112:127], v[132:135], v[140:143], v[112:127]
    s_waitcnt lgkmcnt(0)
    v_mfma_f32_32x32x16_bf16 v[64:79], v[240:243], v[248:251], v[64:79]
    v_mfma_f32_32x32x16_bf16 v[80:95], v[240:243], v[252:255], v[80:95]
    v_mfma_f32_32x32x16_bf16 v[96:111], v[244:247], v[248:251], v[96:111]
    v_mfma_f32_32x32x16_bf16 v[112:127], v[244:247], v[252:255], v[112:127]
    s_barrier
    s_waitcnt vmcnt(0)
    ds_write_b128 v4, v[144:147] offset:0
    ds_write_b128 v4, v[148:151] offset:128
    ds_write_b128 v4, v[152:155] offset:8704
    ds_write_b128 v4, v[156:159] offset:8832
    ds_write_b128 v4, v[160:163] offset:17408
    ds_write_b128 v4, v[164:167] offset:17536
    ds_write_b128 v4, v[168:171] offset:26112
    ds_write_b128 v4, v[172:175] offset:26240
    v_add_u32 v18, 34816, v6
    ds_write_b128 v18, v[176:179]
    ds_write_b128 v18, v[180:183] offset:128
    v_add_u32 v18, 45056, v6
    ds_write_b128 v18, v[184:187]
    ds_write_b128 v18, v[188:191] offset:128
    v_add_u32 v18, 55296, v6
    ds_write_b128 v18, v[192:195]
    ds_write_b128 v18, v[196:199] offset:128
    v_add_u32 v18, 65536, v6
    ds_write_b128 v18, v[200:203]
    ds_write_b128 v18, v[204:207] offset:128
    s_waitcnt lgkmcnt(0)
    s_barrier
    v_add_u32 v3, 256, v3
    v_add_u32 v5, 442368, v5
    v_add_u32 v18, 0, v3
    buffer_load_dwordx4 v[144:147], v18, s[20:23], s29 offen
    v_add_u32 v18, 128, v3
    buffer_load_dwordx4 v[148:151], v18, s[20:23], s29 offen
    v_add_u32 v18, 40960, v3
    buffer_load_dwordx4 v[152:155], v18, s[20:23], s29 offen
    v_add_u32 v18, 41088, v3
    buffer_load_dwordx4 v[156:159], v18, s[20:23], s29 offen
    v_add_u32 v18, 81920, v3
    buffer_load_dwordx4 v[160:163], v18, s[20:23], s29 offen
    v_add_u32 v18, 82048, v3
    buffer_load_dwordx4 v[164:167], v18, s[20:23], s29 offen
    v_add_u32 v18, 122880, v3
    buffer_load_dwordx4 v[168:171], v18, s[20:23], s29 offen
    v_add_u32 v18, 123008, v3
    buffer_load_dwordx4 v[172:175], v18, s[20:23], s29 offen
    v_add_u32 v18, 0, v5
    buffer_load_dwordx4 v[176:179], v18, s[12:15], s30 offen
    buffer_load_dwordx4 v[180:183], v18, s[16:19], s31 offen
    v_add_u32 v18, 110592, v5
    buffer_load_dwordx4 v[184:187], v18, s[12:15], s30 offen
    buffer_load_dwordx4 v[188:191], v18, s[16:19], s31 offen
    v_add_u32 v18, 221184, v5
    buffer_load_dwordx4 v[192:195], v18, s[12:15], s30 offen
    buffer_load_dwordx4 v[196:199], v18, s[16:19], s31 offen
    v_add_u32 v18, 331776, v5
    buffer_load_dwordx4 v[200:203], v18, s[12:15], s30 offen
    buffer_load_dwordx4 v[204:207], v18, s[16:19], s31 offen
    ds_read_b128 v[128:131], v13 offset:0
    ds_read_b128 v[132:135], v13 offset:8704
    ds_read_b64_tr_b16 v[136:137], v15 offset:0
    ds_read_b64_tr_b16 v[138:139], v15 offset:1280
    ds_read_b64_tr_b16 v[140:141], v15 offset:128
    ds_read_b64_tr_b16 v[142:143], v15 offset:1408
    ds_read_b128 v[240:243], v13 offset:32
    ds_read_b128 v[244:247], v13 offset:8736
    ds_read_b64_tr_b16 v[248:249], v15 offset:5120
    ds_read_b64_tr_b16 v[250:251], v15 offset:6400
    ds_read_b64_tr_b16 v[252:253], v15 offset:5248
    ds_read_b64_tr_b16 v[254:255], v15 offset:6528
    s_waitcnt lgkmcnt(6)
    v_mfma_f32_32x32x16_bf16 v[64:79], v[128:131], v[136:139], v[64:79]
    v_mfma_f32_32x32x16_bf16 v[80:95], v[128:131], v[140:143], v[80:95]
    v_mfma_f32_32x32x16_bf16 v[96:111], v[132:135], v[136:139], v[96:111]
    v_mfma_f32_32x32x16_bf16 v[112:127], v[132:135], v[140:143], v[112:127]
    ds_read_b128 v[128:131], v13 offset:64
    ds_read_b128 v[132:135], v13 offset:8768
    ds_read_b64_tr_b16 v[136:137], v15 offset:10240
    ds_read_b64_tr_b16 v[138:139], v15 offset:11520
    ds_read_b64_tr_b16 v[140:141], v15 offset:10368
    ds_read_b64_tr_b16 v[142:143], v15 offset:11648
    s_waitcnt lgkmcnt(6)
    v_mfma_f32_32x32x16_bf16 v[64:79], v[240:243], v[248:251], v[64:79]
    v_mfma_f32_32x32x16_bf16 v[80:95], v[240:243], v[252:255], v[80:95]
    v_mfma_f32_32x32x16_bf16 v[96:111], v[244:247], v[248:251], v[96:111]
    v_mfma_f32_32x32x16_bf16 v[112:127], v[244:247], v[252:255], v[112:127]
    ds_read_b128 v[240:243], v13 offset:96
    ds_read_b128 v[244:247], v13 offset:8800
    ds_read_b64_tr_b16 v[248:249], v15 offset:15360
    ds_read_b64_tr_b16 v[250:251], v15 offset:16640
    ds_read_b64_tr_b16 v[252:253], v15 offset:15488
    ds_read_b64_tr_b16 v[254:255], v15 offset:16768
    s_waitcnt lgkmcnt(6)
    v_mfma_f32_32x32x16_bf16 v[64:79], v[128:131], v[136:139], v[64:79]
    v_mfma_f32_32x32x16_bf16 v[80:95], v[128:131], v[140:143], v[80:95]
    v_mfma_f32_32x32x16_bf16 v[96:111], v[132:135], v[136:139], v[96:111]
    v_mfma_f32_32x32x16_bf16 v[112:127], v[132:135], v[140:143], v[112:127]
    ds_read_b128 v[128:131], v13 offset:128
    ds_read_b128 v[132:135], v13 offset:8832
    ds_read_b64_tr_b16 v[136:137], v15 offset:20480
    ds_read_b64_tr_b16 v[138:139], v15 offset:21760
    ds_read_b64_tr_b16 v[140:141], v15 offset:20608
    ds_read_b64_tr_b16 v[142:143], v15 offset:21888
    s_waitcnt lgkmcnt(6)
    v_mfma_f32_32x32x16_bf16 v[64:79], v[240:243], v[248:251], v[64:79]
    v_mfma_f32_32x32x16_bf16 v[80:95], v[240:243], v[252:255], v[80:95]
    v_mfma_f32_32x32x16_bf16 v[96:111], v[244:247], v[248:251], v[96:111]
    v_mfma_f32_32x32x16_bf16 v[112:127], v[244:247], v[252:255], v[112:127]
    ds_read_b128 v[240:243], v13 offset:160
    ds_read_b128 v[244:247], v13 offset:8864
    ds_read_b64_tr_b16 v[248:249], v15 offset:25600
    ds_read_b64_tr_b16 v[250:251], v15 offset:26880
    ds_read_b64_tr_b16 v[252:253], v15 offset:25728
    ds_read_b64_tr_b16 v[254:255], v15 offset:27008
    s_waitcnt lgkmcnt(6)
    v_mfma_f32_32x32x16_bf16 v[64:79], v[128:131], v[136:139], v[64:79]
    v_mfma_f32_32x32x16_bf16 v[80:95], v[128:131], v[140:143], v[80:95]
    v_mfma_f32_32x32x16_bf16 v[96:111], v[132:135], v[136:139], v[96:111]
    v_mfma_f32_32x32x16_bf16 v[112:127], v[132:135], v[140:143], v[112:127]
    ds_read_b128 v[128:131], v13 offset:192
    ds_read_b128 v[132:135], v13 offset:8896
    ds_read_b64_tr_b16 v[136:137], v15 offset:30720
    ds_read_b64_tr_b16 v[138:139], v15 offset:32000
    ds_read_b64_tr_b16 v[140:141], v15 offset:30848
    ds_read_b64_tr_b16 v[142:143], v15 offset:32128
    s_waitcnt lgkmcnt(6)
    v_mfma_f32_32x32x16_bf16 v[64:79], v[240:243], v[248:251], v[64:79]
    v_mfma_f32_32x32x16_bf16 v[80:95], v[240:243], v[252:255], v[80:95]
    v_mfma_f32_32x32x16_bf16 v[96:111], v[244:247], v[248:251], v[96:111]
    v_mfma_f32_32x32x16_bf16 v[112:127], v[244:247], v[252:255], v[112:127]
    ds_read_b128 v[240:243], v13 offset:224
    ds_read_b128 v[244:247], v13 offset:8928
    ds_read_b64_tr_b16 v[248:249], v15 offset:35840
    ds_read_b64_tr_b16 v[250:251], v15 offset:37120
    ds_read_b64_tr_b16 v[252:253], v15 offset:35968
    ds_read_b64_tr_b16 v[254:255], v15 offset:37248
    s_waitcnt lgkmcnt(6)
    v_mfma_f32_32x32x16_bf16 v[64:79], v[128:131], v[136:139], v[64:79]
    v_mfma_f32_32x32x16_bf16 v[80:95], v[128:131], v[140:143], v[80:95]
    v_mfma_f32_32x32x16_bf16 v[96:111], v[132:135], v[136:139], v[96:111]
    v_mfma_f32_32x32x16_bf16 v[112:127], v[132:135], v[140:143], v[112:127]
    s_waitcnt lgkmcnt(0)
    v_mfma_f32_32x32x16_bf16 v[64:79], v[240:243], v[248:251], v[64:79]
    v_mfma_f32_32x32x16_bf16 v[80:95], v[240:243], v[252:255], v[80:95]
    v_mfma_f32_32x32x16_bf16 v[96:111], v[244:247], v[248:251], v[96:111]
    v_mfma_f32_32x32x16_bf16 v[112:127], v[244:247], v[252:255], v[112:127]
    s_barrier
    s_waitcnt vmcnt(0)
    ds_write_b128 v4, v[144:147] offset:0
    ds_write_b128 v4, v[148:151] offset:128
    ds_write_b128 v4, v[152:155] offset:8704
    ds_write_b128 v4, v[156:159] offset:8832
    ds_write_b128 v4, v[160:163] offset:17408
    ds_write_b128 v4, v[164:167] offset:17536
    ds_write_b128 v4, v[168:171] offset:26112
    ds_write_b128 v4, v[172:175] offset:26240
    v_add_u32 v18, 34816, v6
    ds_write_b128 v18, v[176:179]
    ds_write_b128 v18, v[180:183] offset:128
    v_add_u32 v18, 45056, v6
    ds_write_b128 v18, v[184:187]
    ds_write_b128 v18, v[188:191] offset:128
    v_add_u32 v18, 55296, v6
    ds_write_b128 v18, v[192:195]
    ds_write_b128 v18, v[196:199] offset:128
    v_add_u32 v18, 65536, v6
    ds_write_b128 v18, v[200:203]
    ds_write_b128 v18, v[204:207] offset:128
    s_waitcnt lgkmcnt(0)
    s_barrier
    v_add_u32 v3, 256, v3
    v_add_u32 v5, 442368, v5
    v_add_u32 v18, 0, v3
    buffer_load_dwordx4 v[144:147], v18, s[20:23], s29 offen
    v_add_u32 v18, 128, v3
    buffer_load_dwordx4 v[148:151], v18, s[20:23], s29 offen
    v_add_u32 v18, 40960, v3
    buffer_load_dwordx4 v[152:155], v18, s[20:23], s29 offen
    v_add_u32 v18, 41088, v3
    buffer_load_dwordx4 v[156:159], v18, s[20:23], s29 offen
    v_add_u32 v18, 81920, v3
    buffer_load_dwordx4 v[160:163], v18, s[20:23], s29 offen
    v_add_u32 v18, 82048, v3
    buffer_load_dwordx4 v[164:167], v18, s[20:23], s29 offen
    v_add_u32 v18, 122880, v3
    buffer_load_dwordx4 v[168:171], v18, s[20:23], s29 offen
    v_add_u32 v18, 123008, v3
    buffer_load_dwordx4 v[172:175], v18, s[20:23], s29 offen
    v_add_u32 v18, 0, v5
    buffer_load_dwordx4 v[176:179], v18, s[12:15], s30 offen
    buffer_load_dwordx4 v[180:183], v18, s[16:19], s31 offen
    v_add_u32 v18, 110592, v5
    buffer_load_dwordx4 v[184:187], v18, s[12:15], s30 offen
    buffer_load_dwordx4 v[188:191], v18, s[16:19], s31 offen
    v_add_u32 v18, 221184, v5
    buffer_load_dwordx4 v[192:195], v18, s[12:15], s30 offen
    buffer_load_dwordx4 v[196:199], v18, s[16:19], s31 offen
    v_add_u32 v18, 331776, v5
    buffer_load_dwordx4 v[200:203], v18, s[12:15], s30 offen
    buffer_load_dwordx4 v[204:207], v18, s[16:19], s31 offen
    ds_read_b128 v[128:131], v13 offset:0
    ds_read_b128 v[132:135], v13 offset:8704
    ds_read_b64_tr_b16 v[136:137], v15 offset:0
    ds_read_b64_tr_b16 v[138:139], v15 offset:1280
    ds_read_b64_tr_b16 v[140:141], v15 offset:128
    ds_read_b64_tr_b16 v[142:143], v15 offset:1408
    ds_read_b128 v[240:243], v13 offset:32
    ds_read_b128 v[244:247], v13 offset:8736
    ds_read_b64_tr_b16 v[248:249], v15 offset:5120
    ds_read_b64_tr_b16 v[250:251], v15 offset:6400
    ds_read_b64_tr_b16 v[252:253], v15 offset:5248
    ds_read_b64_tr_b16 v[254:255], v15 offset:6528
    s_waitcnt lgkmcnt(6)
    v_mfma_f32_32x32x16_bf16 v[64:79], v[128:131], v[136:139], v[64:79]
    v_mfma_f32_32x32x16_bf16 v[80:95], v[128:131], v[140:143], v[80:95]
    v_mfma_f32_32x32x16_bf16 v[96:111], v[132:135], v[136:139], v[96:111]
    v_mfma_f32_32x32x16_bf16 v[112:127], v[132:135], v[140:143], v[112:127]
    ds_read_b128 v[128:131], v13 offset:64
    ds_read_b128 v[132:135], v13 offset:8768
    ds_read_b64_tr_b16 v[136:137], v15 offset:10240
    ds_read_b64_tr_b16 v[138:139], v15 offset:11520
    ds_read_b64_tr_b16 v[140:141], v15 offset:10368
    ds_read_b64_tr_b16 v[142:143], v15 offset:11648
    s_waitcnt lgkmcnt(6)
    v_mfma_f32_32x32x16_bf16 v[64:79], v[240:243], v[248:251], v[64:79]
    v_mfma_f32_32x32x16_bf16 v[80:95], v[240:243], v[252:255], v[80:95]
    v_mfma_f32_32x32x16_bf16 v[96:111], v[244:247], v[248:251], v[96:111]
    v_mfma_f32_32x32x16_bf16 v[112:127], v[244:247], v[252:255], v[112:127]
    ds_read_b128 v[240:243], v13 offset:96
    ds_read_b128 v[244:247], v13 offset:8800
    ds_read_b64_tr_b16 v[248:249], v15 offset:15360
    ds_read_b64_tr_b16 v[250:251], v15 offset:16640
    ds_read_b64_tr_b16 v[252:253], v15 offset:15488
    ds_read_b64_tr_b16 v[254:255], v15 offset:16768
    s_waitcnt lgkmcnt(6)
    v_mfma_f32_32x32x16_bf16 v[64:79], v[128:131], v[136:139], v[64:79]
    v_mfma_f32_32x32x16_bf16 v[80:95], v[128:131], v[140:143], v[80:95]
    v_mfma_f32_32x32x16_bf16 v[96:111], v[132:135], v[136:139], v[96:111]
    v_mfma_f32_32x32x16_bf16 v[112:127], v[132:135], v[140:143], v[112:127]
    ds_read_b128 v[128:131], v13 offset:128
    ds_read_b128 v[132:135], v13 offset:8832
    ds_read_b64_tr_b16 v[136:137], v15 offset:20480
    ds_read_b64_tr_b16 v[138:139], v15 offset:21760
    ds_read_b64_tr_b16 v[140:141], v15 offset:20608
    ds_read_b64_tr_b16 v[142:143], v15 offset:21888
    s_waitcnt lgkmcnt(6)
    v_mfma_f32_32x32x16_bf16 v[64:79], v[240:243], v[248:251], v[64:79]
    v_mfma_f32_32x32x16_bf16 v[80:95], v[240:243], v[252:255], v[80:95]
    v_mfma_f32_32x32x16_bf16 v[96:111], v[244:247], v[248:251], v[96:111]
    v_mfma_f32_32x32x16_bf16 v[112:127], v[244:247], v[252:255], v[112:127]
    ds_read_b128 v[240:243], v13 offset:160
    ds_read_b128 v[244:247], v13 offset:8864
    ds_read_b64_tr_b16 v[248:249], v15 offset:25600
    ds_read_b64_tr_b16 v[250:251], v15 offset:26880
    ds_read_b64_tr_b16 v[252:253], v15 offset:25728
    ds_read_b64_tr_b16 v[254:255], v15 offset:27008
    s_waitcnt lgkmcnt(6)
    v_mfma_f32_32x32x16_bf16 v[64:79], v[128:131], v[136:139], v[64:79]
    v_mfma_f32_32x32x16_bf16 v[80:95], v[128:131], v[140:143], v[80:95]
    v_mfma_f32_32x32x16_bf16 v[96:111], v[132:135], v[136:139], v[96:111]
    v_mfma_f32_32x32x16_bf16 v[112:127], v[132:135], v[140:143], v[112:127]
    ds_read_b128 v[128:131], v13 offset:192
    ds_read_b128 v[132:135], v13 offset:8896
    ds_read_b64_tr_b16 v[136:137], v15 offset:30720
    ds_read_b64_tr_b16 v[138:139], v15 offset:32000
    ds_read_b64_tr_b16 v[140:141], v15 offset:30848
    ds_read_b64_tr_b16 v[142:143], v15 offset:32128
    s_waitcnt lgkmcnt(6)
    v_mfma_f32_32x32x16_bf16 v[64:79], v[240:243], v[248:251], v[64:79]
    v_mfma_f32_32x32x16_bf16 v[80:95], v[240:243], v[252:255], v[80:95]
    v_mfma_f32_32x32x16_bf16 v[96:111], v[244:247], v[248:251], v[96:111]
    v_mfma_f32_32x32x16_bf16 v[112:127], v[244:247], v[252:255], v[112:127]
    ds_read_b128 v[240:243], v13 offset:224
    ds_read_b128 v[244:247], v13 offset:8928
    ds_read_b64_tr_b16 v[248:249], v15 offset:35840
    ds_read_b64_tr_b16 v[250:251], v15 offset:37120
    ds_read_b64_tr_b16 v[252:253], v15 offset:35968
    ds_read_b64_tr_b16 v[254:255], v15 offset:37248
    s_waitcnt lgkmcnt(6)
    v_mfma_f32_32x32x16_bf16 v[64:79], v[128:131], v[136:139], v[64:79]
    v_mfma_f32_32x32x16_bf16 v[80:95], v[128:131], v[140:143], v[80:95]
    v_mfma_f32_32x32x16_bf16 v[96:111], v[132:135], v[136:139], v[96:111]
    v_mfma_f32_32x32x16_bf16 v[112:127], v[132:135], v[140:143], v[112:127]
    s_waitcnt lgkmcnt(0)
    v_mfma_f32_32x32x16_bf16 v[64:79], v[240:243], v[248:251], v[64:79]
    v_mfma_f32_32x32x16_bf16 v[80:95], v[240:243], v[252:255], v[80:95]
    v_mfma_f32_32x32x16_bf16 v[96:111], v[244:247], v[248:251], v[96:111]
    v_mfma_f32_32x32x16_bf16 v[112:127], v[244:247], v[252:255], v[112:127]
    s_barrier
    s_waitcnt vmcnt(0)
    ds_write_b128 v4, v[144:147] offset:0
    ds_write_b128 v4, v[148:151] offset:128
    ds_write_b128 v4, v[152:155] offset:8704
    ds_write_b128 v4, v[156:159] offset:8832
    ds_write_b128 v4, v[160:163] offset:17408
    ds_write_b128 v4, v[164:167] offset:17536
    ds_write_b128 v4, v[168:171] offset:26112
    ds_write_b128 v4, v[172:175] offset:26240
    v_add_u32 v18, 34816, v6
    ds_write_b128 v18, v[176:179]
    ds_write_b128 v18, v[180:183] offset:128
    v_add_u32 v18, 45056, v6
    ds_write_b128 v18, v[184:187]
    ds_write_b128 v18, v[188:191] offset:128
    v_add_u32 v18, 55296, v6
    ds_write_b128 v18, v[192:195]
    ds_write_b128 v18, v[196:199] offset:128
    v_add_u32 v18, 65536, v6
    ds_write_b128 v18, v[200:203]
    ds_write_b128 v18, v[204:207] offset:128
    s_waitcnt lgkmcnt(0)
    s_barrier
    ds_read_b128 v[128:131], v13 offset:0
    ds_read_b128 v[132:135], v13 offset:8704
    ds_read_b64_tr_b16 v[136:137], v15 offset:0
    ds_read_b64_tr_b16 v[138:139], v15 offset:1280
    ds_read_b64_tr_b16 v[140:141], v15 offset:128
    ds_read_b64_tr_b16 v[142:143], v15 offset:1408
    ds_read_b128 v[240:243], v13 offset:32
    ds_read_b128 v[244:247], v13 offset:8736
    ds_read_b64_tr_b16 v[248:249], v15 offset:5120
    ds_read_b64_tr_b16 v[250:251], v15 offset:6400
    ds_read_b64_tr_b16 v[252:253], v15 offset:5248
    ds_read_b64_tr_b16 v[254:255], v15 offset:6528
    s_waitcnt lgkmcnt(6)
    v_mfma_f32_32x32x16_bf16 v[64:79], v[128:131], v[136:139], v[64:79]
    v_mfma_f32_32x32x16_bf16 v[80:95], v[128:131], v[140:143], v[80:95]
    v_mfma_f32_32x32x16_bf16 v[96:111], v[132:135], v[136:139], v[96:111]
    v_mfma_f32_32x32x16_bf16 v[112:127], v[132:135], v[140:143], v[112:127]
    ds_read_b128 v[128:131], v13 offset:64
    ds_read_b128 v[132:135], v13 offset:8768
    ds_read_b64_tr_b16 v[136:137], v15 offset:10240
    ds_read_b64_tr_b16 v[138:139], v15 offset:11520
    ds_read_b64_tr_b16 v[140:141], v15 offset:10368
    ds_read_b64_tr_b16 v[142:143], v15 offset:11648
    s_waitcnt lgkmcnt(6)
    v_mfma_f32_32x32x16_bf16 v[64:79], v[240:243], v[248:251], v[64:79]
    v_mfma_f32_32x32x16_bf16 v[80:95], v[240:243], v[252:255], v[80:95]
    v_mfma_f32_32x32x16_bf16 v[96:111], v[244:247], v[248:251], v[96:111]
    v_mfma_f32_32x32x16_bf16 v[112:127], v[244:247], v[252:255], v[112:127]
    ds_read_b128 v[240:243], v13 offset:96
    ds_read_b128 v[244:247], v13 offset:8800
    ds_read_b64_tr_b16 v[248:249], v15 offset:15360
    ds_read_b64_tr_b16 v[250:251], v15 offset:16640
    ds_read_b64_tr_b16 v[252:253], v15 offset:15488
    ds_read_b64_tr_b16 v[254:255], v15 offset:16768
    s_waitcnt lgkmcnt(6)
    v_mfma_f32_32x32x16_bf16 v[64:79], v[128:131], v[136:139], v[64:79]
    v_mfma_f32_32x32x16_bf16 v[80:95], v[128:131], v[140:143], v[80:95]
    v_mfma_f32_32x32x16_bf16 v[96:111], v[132:135], v[136:139], v[96:111]
    v_mfma_f32_32x32x16_bf16 v[112:127], v[132:135], v[140:143], v[112:127]
    ds_read_b128 v[128:131], v13 offset:128
    ds_read_b128 v[132:135], v13 offset:8832
    ds_read_b64_tr_b16 v[136:137], v15 offset:20480
    ds_read_b64_tr_b16 v[138:139], v15 offset:21760
    ds_read_b64_tr_b16 v[140:141], v15 offset:20608
    ds_read_b64_tr_b16 v[142:143], v15 offset:21888
    s_waitcnt lgkmcnt(6)
    v_mfma_f32_32x32x16_bf16 v[64:79], v[240:243], v[248:251], v[64:79]
    v_mfma_f32_32x32x16_bf16 v[80:95], v[240:243], v[252:255], v[80:95]
    v_mfma_f32_32x32x16_bf16 v[96:111], v[244:247], v[248:251], v[96:111]
    v_mfma_f32_32x32x16_bf16 v[112:127], v[244:247], v[252:255], v[112:127]
    ds_read_b128 v[240:243], v13 offset:160
    ds_read_b128 v[244:247], v13 offset:8864
    ds_read_b64_tr_b16 v[248:249], v15 offset:25600
    ds_read_b64_tr_b16 v[250:251], v15 offset:26880
    ds_read_b64_tr_b16 v[252:253], v15 offset:25728
    ds_read_b64_tr_b16 v[254:255], v15 offset:27008
    s_waitcnt lgkmcnt(6)
    v_mfma_f32_32x32x16_bf16 v[64:79], v[128:131], v[136:139], v[64:79]
    v_mfma_f32_32x32x16_bf16 v[80:95], v[128:131], v[140:143], v[80:95]
    v_mfma_f32_32x32x16_bf16 v[96:111], v[132:135], v[136:139], v[96:111]
    v_mfma_f32_32x32x16_bf16 v[112:127], v[132:135], v[140:143], v[112:127]
    ds_read_b128 v[128:131], v13 offset:192
    ds_read_b128 v[132:135], v13 offset:8896
    ds_read_b64_tr_b16 v[136:137], v15 offset:30720
    ds_read_b64_tr_b16 v[138:139], v15 offset:32000
    ds_read_b64_tr_b16 v[140:141], v15 offset:30848
    ds_read_b64_tr_b16 v[142:143], v15 offset:32128
    s_waitcnt lgkmcnt(6)
    v_mfma_f32_32x32x16_bf16 v[64:79], v[240:243], v[248:251], v[64:79]
    v_mfma_f32_32x32x16_bf16 v[80:95], v[240:243], v[252:255], v[80:95]
    v_mfma_f32_32x32x16_bf16 v[96:111], v[244:247], v[248:251], v[96:111]
    v_mfma_f32_32x32x16_bf16 v[112:127], v[244:247], v[252:255], v[112:127]
    ds_read_b128 v[240:243], v13 offset:224
    ds_read_b128 v[244:247], v13 offset:8928
    ds_read_b64_tr_b16 v[248:249], v15 offset:35840
    ds_read_b64_tr_b16 v[250:251], v15 offset:37120
    ds_read_b64_tr_b16 v[252:253], v15 offset:35968
    ds_read_b64_tr_b16 v[254:255], v15 offset:37248
    s_waitcnt lgkmcnt(6)
    v_mfma_f32_32x32x16_bf16 v[64:79], v[128:131], v[136:139], v[64:79]
    v_mfma_f32_32x32x16_bf16 v[80:95], v[128:131], v[140:143], v[80:95]
    v_mfma_f32_32x32x16_bf16 v[96:111], v[132:135], v[136:139], v[96:111]
    v_mfma_f32_32x32x16_bf16 v[112:127], v[132:135], v[140:143], v[112:127]
    s_waitcnt lgkmcnt(0)
    v_mfma_f32_32x32x16_bf16 v[64:79], v[240:243], v[248:251], v[64:79]
    v_mfma_f32_32x32x16_bf16 v[80:95], v[240:243], v[252:255], v[80:95]
    v_mfma_f32_32x32x16_bf16 v[96:111], v[244:247], v[248:251], v[96:111]
    v_mfma_f32_32x32x16_bf16 v[112:127], v[244:247], v[252:255], v[112:127]
    s_barrier
    s_nop 15
    v_mul_u32_u24 v20, 64, v9
    v_add_u32 v20, s27, v20
    v_lshl_add_u32 v20, v12, 2, v20
    v_lshl_add_u32 v21, v10, 5, v11
    s_movk_i32 s28, 3456
    v_mul_lo_u32 v22, v20, s28
    v_lshl_add_u32 v22, v21, 1, v22
    v_add_u32 v22, s30, v22
    s_mov_b32 s33, 16777216
    s_mov_b32 s34, 0xbfb8aa3b
    v_cvt_pk_bf16_f32 v64, v64, v64
    v_lshlrev_b32 v64, 16, v64
    v_cvt_pk_bf16_f32 v80, v80, v80
    v_lshlrev_b32 v80, 16, v80
    v_mul_f32 v23, s34, v64
    v_exp_f32 v23, v23
    s_nop 0
    v_add_f32 v23, 1.0, v23
    v_rcp_f32 v23, v23
    s_nop 0
    v_mul_f32 v23, v23, v64
    v_cvt_pk_bf16_f32 v23, v23, v23
    v_lshlrev_b32 v23, 16, v23
    v_mul_f32 v23, v23, v80
    v_cvt_pk_bf16_f32 v23, v23, v23
    v_add_u32 v24, 0, v22
    buffer_store_short v23, v24, s[20:23], s33 offen
    v_cvt_pk_bf16_f32 v65, v65, v65
    v_lshlrev_b32 v65, 16, v65
    v_cvt_pk_bf16_f32 v81, v81, v81
    v_lshlrev_b32 v81, 16, v81
    v_mul_f32 v23, s34, v65
    v_exp_f32 v23, v23
    s_nop 0
    v_add_f32 v23, 1.0, v23
    v_rcp_f32 v23, v23
    s_nop 0
    v_mul_f32 v23, v23, v65
    v_cvt_pk_bf16_f32 v23, v23, v23
    v_lshlrev_b32 v23, 16, v23
    v_mul_f32 v23, v23, v81
    v_cvt_pk_bf16_f32 v23, v23, v23
    v_add_u32 v24, 3456, v22
    buffer_store_short v23, v24, s[20:23], s33 offen
    v_cvt_pk_bf16_f32 v66, v66, v66
    v_lshlrev_b32 v66, 16, v66
    v_cvt_pk_bf16_f32 v82, v82, v82
    v_lshlrev_b32 v82, 16, v82
    v_mul_f32 v23, s34, v66
    v_exp_f32 v23, v23
    s_nop 0
    v_add_f32 v23, 1.0, v23
    v_rcp_f32 v23, v23
    s_nop 0
    v_mul_f32 v23, v23, v66
    v_cvt_pk_bf16_f32 v23, v23, v23
    v_lshlrev_b32 v23, 16, v23
    v_mul_f32 v23, v23, v82
    v_cvt_pk_bf16_f32 v23, v23, v23
    v_add_u32 v24, 6912, v22
    buffer_store_short v23, v24, s[20:23], s33 offen
    v_cvt_pk_bf16_f32 v67, v67, v67
    v_lshlrev_b32 v67, 16, v67
    v_cvt_pk_bf16_f32 v83, v83, v83
    v_lshlrev_b32 v83, 16, v83
    v_mul_f32 v23, s34, v67
    v_exp_f32 v23, v23
    s_nop 0
    v_add_f32 v23, 1.0, v23
    v_rcp_f32 v23, v23
    s_nop 0
    v_mul_f32 v23, v23, v67
    v_cvt_pk_bf16_f32 v23, v23, v23
    v_lshlrev_b32 v23, 16, v23
    v_mul_f32 v23, v23, v83
    v_cvt_pk_bf16_f32 v23, v23, v23
    v_add_u32 v24, 10368, v22
    buffer_store_short v23, v24, s[20:23], s33 offen
    v_cvt_pk_bf16_f32 v68, v68, v68
    v_lshlrev_b32 v68, 16, v68
    v_cvt_pk_bf16_f32 v84, v84, v84
    v_lshlrev_b32 v84, 16, v84
    v_mul_f32 v23, s34, v68
    v_exp_f32 v23, v23
    s_nop 0
    v_add_f32 v23, 1.0, v23
    v_rcp_f32 v23, v23
    s_nop 0
    v_mul_f32 v23, v23, v68
    v_cvt_pk_bf16_f32 v23, v23, v23
    v_lshlrev_b32 v23, 16, v23
    v_mul_f32 v23, v23, v84
    v_cvt_pk_bf16_f32 v23, v23, v23
    v_add_u32 v24, 27648, v22
    buffer_store_short v23, v24, s[20:23], s33 offen
    v_cvt_pk_bf16_f32 v69, v69, v69
    v_lshlrev_b32 v69, 16, v69
    v_cvt_pk_bf16_f32 v85, v85, v85
    v_lshlrev_b32 v85, 16, v85
    v_mul_f32 v23, s34, v69
    v_exp_f32 v23, v23
    s_nop 0
    v_add_f32 v23, 1.0, v23
    v_rcp_f32 v23, v23
    s_nop 0
    v_mul_f32 v23, v23, v69
    v_cvt_pk_bf16_f32 v23, v23, v23
    v_lshlrev_b32 v23, 16, v23
    v_mul_f32 v23, v23, v85
    v_cvt_pk_bf16_f32 v23, v23, v23
    v_add_u32 v24, 31104, v22
    buffer_store_short v23, v24, s[20:23], s33 offen
    v_cvt_pk_bf16_f32 v70, v70, v70
    v_lshlrev_b32 v70, 16, v70
    v_cvt_pk_bf16_f32 v86, v86, v86
    v_lshlrev_b32 v86, 16, v86
    v_mul_f32 v23, s34, v70
    v_exp_f32 v23, v23
    s_nop 0
    v_add_f32 v23, 1.0, v23
    v_rcp_f32 v23, v23
    s_nop 0
    v_mul_f32 v23, v23, v70
    v_cvt_pk_bf16_f32 v23, v23, v23
    v_lshlrev_b32 v23, 16, v23
    v_mul_f32 v23, v23, v86
    v_cvt_pk_bf16_f32 v23, v23, v23
    v_add_u32 v24, 34560, v22
    buffer_store_short v23, v24, s[20:23], s33 offen
    v_cvt_pk_bf16_f32 v71, v71, v71
    v_lshlrev_b32 v71, 16, v71
    v_cvt_pk_bf16_f32 v87, v87, v87
    v_lshlrev_b32 v87, 16, v87
    v_mul_f32 v23, s34, v71
    v_exp_f32 v23, v23
    s_nop 0
    v_add_f32 v23, 1.0, v23
    v_rcp_f32 v23, v23
    s_nop 0
    v_mul_f32 v23, v23, v71
    v_cvt_pk_bf16_f32 v23, v23, v23
    v_lshlrev_b32 v23, 16, v23
    v_mul_f32 v23, v23, v87
    v_cvt_pk_bf16_f32 v23, v23, v23
    v_add_u32 v24, 38016, v22
    buffer_store_short v23, v24, s[20:23], s33 offen
    v_cvt_pk_bf16_f32 v72, v72, v72
    v_lshlrev_b32 v72, 16, v72
    v_cvt_pk_bf16_f32 v88, v88, v88
    v_lshlrev_b32 v88, 16, v88
    v_mul_f32 v23, s34, v72
    v_exp_f32 v23, v23
    s_nop 0
    v_add_f32 v23, 1.0, v23
    v_rcp_f32 v23, v23
    s_nop 0
    v_mul_f32 v23, v23, v72
    v_cvt_pk_bf16_f32 v23, v23, v23
    v_lshlrev_b32 v23, 16, v23
    v_mul_f32 v23, v23, v88
    v_cvt_pk_bf16_f32 v23, v23, v23
    v_add_u32 v24, 55296, v22
    buffer_store_short v23, v24, s[20:23], s33 offen
    v_cvt_pk_bf16_f32 v73, v73, v73
    v_lshlrev_b32 v73, 16, v73
    v_cvt_pk_bf16_f32 v89, v89, v89
    v_lshlrev_b32 v89, 16, v89
    v_mul_f32 v23, s34, v73
    v_exp_f32 v23, v23
    s_nop 0
    v_add_f32 v23, 1.0, v23
    v_rcp_f32 v23, v23
    s_nop 0
    v_mul_f32 v23, v23, v73
    v_cvt_pk_bf16_f32 v23, v23, v23
    v_lshlrev_b32 v23, 16, v23
    v_mul_f32 v23, v23, v89
    v_cvt_pk_bf16_f32 v23, v23, v23
    v_add_u32 v24, 58752, v22
    buffer_store_short v23, v24, s[20:23], s33 offen
    v_cvt_pk_bf16_f32 v74, v74, v74
    v_lshlrev_b32 v74, 16, v74
    v_cvt_pk_bf16_f32 v90, v90, v90
    v_lshlrev_b32 v90, 16, v90
    v_mul_f32 v23, s34, v74
    v_exp_f32 v23, v23
    s_nop 0
    v_add_f32 v23, 1.0, v23
    v_rcp_f32 v23, v23
    s_nop 0
    v_mul_f32 v23, v23, v74
    v_cvt_pk_bf16_f32 v23, v23, v23
    v_lshlrev_b32 v23, 16, v23
    v_mul_f32 v23, v23, v90
    v_cvt_pk_bf16_f32 v23, v23, v23
    v_add_u32 v24, 62208, v22
    buffer_store_short v23, v24, s[20:23], s33 offen
    v_cvt_pk_bf16_f32 v75, v75, v75
    v_lshlrev_b32 v75, 16, v75
    v_cvt_pk_bf16_f32 v91, v91, v91
    v_lshlrev_b32 v91, 16, v91
    v_mul_f32 v23, s34, v75
    v_exp_f32 v23, v23
    s_nop 0
    v_add_f32 v23, 1.0, v23
    v_rcp_f32 v23, v23
    s_nop 0
    v_mul_f32 v23, v23, v75
    v_cvt_pk_bf16_f32 v23, v23, v23
    v_lshlrev_b32 v23, 16, v23
    v_mul_f32 v23, v23, v91
    v_cvt_pk_bf16_f32 v23, v23, v23
    v_add_u32 v24, 65664, v22
    buffer_store_short v23, v24, s[20:23], s33 offen
    v_cvt_pk_bf16_f32 v76, v76, v76
    v_lshlrev_b32 v76, 16, v76
    v_cvt_pk_bf16_f32 v92, v92, v92
    v_lshlrev_b32 v92, 16, v92
    v_mul_f32 v23, s34, v76
    v_exp_f32 v23, v23
    s_nop 0
    v_add_f32 v23, 1.0, v23
    v_rcp_f32 v23, v23
    s_nop 0
    v_mul_f32 v23, v23, v76
    v_cvt_pk_bf16_f32 v23, v23, v23
    v_lshlrev_b32 v23, 16, v23
    v_mul_f32 v23, v23, v92
    v_cvt_pk_bf16_f32 v23, v23, v23
    v_add_u32 v24, 82944, v22
    buffer_store_short v23, v24, s[20:23], s33 offen
    v_cvt_pk_bf16_f32 v77, v77, v77
    v_lshlrev_b32 v77, 16, v77
    v_cvt_pk_bf16_f32 v93, v93, v93
    v_lshlrev_b32 v93, 16, v93
    v_mul_f32 v23, s34, v77
    v_exp_f32 v23, v23
    s_nop 0
    v_add_f32 v23, 1.0, v23
    v_rcp_f32 v23, v23
    s_nop 0
    v_mul_f32 v23, v23, v77
    v_cvt_pk_bf16_f32 v23, v23, v23
    v_lshlrev_b32 v23, 16, v23
    v_mul_f32 v23, v23, v93
    v_cvt_pk_bf16_f32 v23, v23, v23
    v_add_u32 v24, 86400, v22
    buffer_store_short v23, v24, s[20:23], s33 offen
    v_cvt_pk_bf16_f32 v78, v78, v78
    v_lshlrev_b32 v78, 16, v78
    v_cvt_pk_bf16_f32 v94, v94, v94
    v_lshlrev_b32 v94, 16, v94
    v_mul_f32 v23, s34, v78
    v_exp_f32 v23, v23
    s_nop 0
    v_add_f32 v23, 1.0, v23
    v_rcp_f32 v23, v23
    s_nop 0
    v_mul_f32 v23, v23, v78
    v_cvt_pk_bf16_f32 v23, v23, v23
    v_lshlrev_b32 v23, 16, v23
    v_mul_f32 v23, v23, v94
    v_cvt_pk_bf16_f32 v23, v23, v23
    v_add_u32 v24, 89856, v22
    buffer_store_short v23, v24, s[20:23], s33 offen
    v_cvt_pk_bf16_f32 v79, v79, v79
    v_lshlrev_b32 v79, 16, v79
    v_cvt_pk_bf16_f32 v95, v95, v95
    v_lshlrev_b32 v95, 16, v95
    v_mul_f32 v23, s34, v79
    v_exp_f32 v23, v23
    s_nop 0
    v_add_f32 v23, 1.0, v23
    v_rcp_f32 v23, v23
    s_nop 0
    v_mul_f32 v23, v23, v79
    v_cvt_pk_bf16_f32 v23, v23, v23
    v_lshlrev_b32 v23, 16, v23
    v_mul_f32 v23, v23, v95
    v_cvt_pk_bf16_f32 v23, v23, v23
    v_add_u32 v24, 93312, v22
    buffer_store_short v23, v24, s[20:23], s33 offen
    v_cvt_pk_bf16_f32 v96, v96, v96
    v_lshlrev_b32 v96, 16, v96
    v_cvt_pk_bf16_f32 v112, v112, v112
    v_lshlrev_b32 v112, 16, v112
    v_mul_f32 v23, s34, v96
    v_exp_f32 v23, v23
    s_nop 0
    v_add_f32 v23, 1.0, v23
    v_rcp_f32 v23, v23
    s_nop 0
    v_mul_f32 v23, v23, v96
    v_cvt_pk_bf16_f32 v23, v23, v23
    v_lshlrev_b32 v23, 16, v23
    v_mul_f32 v23, v23, v112
    v_cvt_pk_bf16_f32 v23, v23, v23
    v_add_u32 v24, 110592, v22
    buffer_store_short v23, v24, s[20:23], s33 offen
    v_cvt_pk_bf16_f32 v97, v97, v97
    v_lshlrev_b32 v97, 16, v97
    v_cvt_pk_bf16_f32 v113, v113, v113
    v_lshlrev_b32 v113, 16, v113
    v_mul_f32 v23, s34, v97
    v_exp_f32 v23, v23
    s_nop 0
    v_add_f32 v23, 1.0, v23
    v_rcp_f32 v23, v23
    s_nop 0
    v_mul_f32 v23, v23, v97
    v_cvt_pk_bf16_f32 v23, v23, v23
    v_lshlrev_b32 v23, 16, v23
    v_mul_f32 v23, v23, v113
    v_cvt_pk_bf16_f32 v23, v23, v23
    v_add_u32 v24, 114048, v22
    buffer_store_short v23, v24, s[20:23], s33 offen
    v_cvt_pk_bf16_f32 v98, v98, v98
    v_lshlrev_b32 v98, 16, v98
    v_cvt_pk_bf16_f32 v114, v114, v114
    v_lshlrev_b32 v114, 16, v114
    v_mul_f32 v23, s34, v98
    v_exp_f32 v23, v23
    s_nop 0
    v_add_f32 v23, 1.0, v23
    v_rcp_f32 v23, v23
    s_nop 0
    v_mul_f32 v23, v23, v98
    v_cvt_pk_bf16_f32 v23, v23, v23
    v_lshlrev_b32 v23, 16, v23
    v_mul_f32 v23, v23, v114
    v_cvt_pk_bf16_f32 v23, v23, v23
    v_add_u32 v24, 117504, v22
    buffer_store_short v23, v24, s[20:23], s33 offen
    v_cvt_pk_bf16_f32 v99, v99, v99
    v_lshlrev_b32 v99, 16, v99
    v_cvt_pk_bf16_f32 v115, v115, v115
    v_lshlrev_b32 v115, 16, v115
    v_mul_f32 v23, s34, v99
    v_exp_f32 v23, v23
    s_nop 0
    v_add_f32 v23, 1.0, v23
    v_rcp_f32 v23, v23
    s_nop 0
    v_mul_f32 v23, v23, v99
    v_cvt_pk_bf16_f32 v23, v23, v23
    v_lshlrev_b32 v23, 16, v23
    v_mul_f32 v23, v23, v115
    v_cvt_pk_bf16_f32 v23, v23, v23
    v_add_u32 v24, 120960, v22
    buffer_store_short v23, v24, s[20:23], s33 offen
    v_cvt_pk_bf16_f32 v100, v100, v100
    v_lshlrev_b32 v100, 16, v100
    v_cvt_pk_bf16_f32 v116, v116, v116
    v_lshlrev_b32 v116, 16, v116
    v_mul_f32 v23, s34, v100
    v_exp_f32 v23, v23
    s_nop 0
    v_add_f32 v23, 1.0, v23
    v_rcp_f32 v23, v23
    s_nop 0
    v_mul_f32 v23, v23, v100
    v_cvt_pk_bf16_f32 v23, v23, v23
    v_lshlrev_b32 v23, 16, v23
    v_mul_f32 v23, v23, v116
    v_cvt_pk_bf16_f32 v23, v23, v23
    v_add_u32 v24, 138240, v22
    buffer_store_short v23, v24, s[20:23], s33 offen
    v_cvt_pk_bf16_f32 v101, v101, v101
    v_lshlrev_b32 v101, 16, v101
    v_cvt_pk_bf16_f32 v117, v117, v117
    v_lshlrev_b32 v117, 16, v117
    v_mul_f32 v23, s34, v101
    v_exp_f32 v23, v23
    s_nop 0
    v_add_f32 v23, 1.0, v23
    v_rcp_f32 v23, v23
    s_nop 0
    v_mul_f32 v23, v23, v101
    v_cvt_pk_bf16_f32 v23, v23, v23
    v_lshlrev_b32 v23, 16, v23
    v_mul_f32 v23, v23, v117
    v_cvt_pk_bf16_f32 v23, v23, v23
    v_add_u32 v24, 141696, v22
    buffer_store_short v23, v24, s[20:23], s33 offen
    v_cvt_pk_bf16_f32 v102, v102, v102
    v_lshlrev_b32 v102, 16, v102
    v_cvt_pk_bf16_f32 v118, v118, v118
    v_lshlrev_b32 v118, 16, v118
    v_mul_f32 v23, s34, v102
    v_exp_f32 v23, v23
    s_nop 0
    v_add_f32 v23, 1.0, v23
    v_rcp_f32 v23, v23
    s_nop 0
    v_mul_f32 v23, v23, v102
    v_cvt_pk_bf16_f32 v23, v23, v23
    v_lshlrev_b32 v23, 16, v23
    v_mul_f32 v23, v23, v118
    v_cvt_pk_bf16_f32 v23, v23, v23
    v_add_u32 v24, 145152, v22
    buffer_store_short v23, v24, s[20:23], s33 offen
    v_cvt_pk_bf16_f32 v103, v103, v103
    v_lshlrev_b32 v103, 16, v103
    v_cvt_pk_bf16_f32 v119, v119, v119
    v_lshlrev_b32 v119, 16, v119
    v_mul_f32 v23, s34, v103
    v_exp_f32 v23, v23
    s_nop 0
    v_add_f32 v23, 1.0, v23
    v_rcp_f32 v23, v23
    s_nop 0
    v_mul_f32 v23, v23, v103
    v_cvt_pk_bf16_f32 v23, v23, v23
    v_lshlrev_b32 v23, 16, v23
    v_mul_f32 v23, v23, v119
    v_cvt_pk_bf16_f32 v23, v23, v23
    v_add_u32 v24, 148608, v22
    buffer_store_short v23, v24, s[20:23], s33 offen
    v_cvt_pk_bf16_f32 v104, v104, v104
    v_lshlrev_b32 v104, 16, v104
    v_cvt_pk_bf16_f32 v120, v120, v120
    v_lshlrev_b32 v120, 16, v120
    v_mul_f32 v23, s34, v104
    v_exp_f32 v23, v23
    s_nop 0
    v_add_f32 v23, 1.0, v23
    v_rcp_f32 v23, v23
    s_nop 0
    v_mul_f32 v23, v23, v104
    v_cvt_pk_bf16_f32 v23, v23, v23
    v_lshlrev_b32 v23, 16, v23
    v_mul_f32 v23, v23, v120
    v_cvt_pk_bf16_f32 v23, v23, v23
    v_add_u32 v24, 165888, v22
    buffer_store_short v23, v24, s[20:23], s33 offen
    v_cvt_pk_bf16_f32 v105, v105, v105
    v_lshlrev_b32 v105, 16, v105
    v_cvt_pk_bf16_f32 v121, v121, v121
    v_lshlrev_b32 v121, 16, v121
    v_mul_f32 v23, s34, v105
    v_exp_f32 v23, v23
    s_nop 0
    v_add_f32 v23, 1.0, v23
    v_rcp_f32 v23, v23
    s_nop 0
    v_mul_f32 v23, v23, v105
    v_cvt_pk_bf16_f32 v23, v23, v23
    v_lshlrev_b32 v23, 16, v23
    v_mul_f32 v23, v23, v121
    v_cvt_pk_bf16_f32 v23, v23, v23
    v_add_u32 v24, 169344, v22
    buffer_store_short v23, v24, s[20:23], s33 offen
    v_cvt_pk_bf16_f32 v106, v106, v106
    v_lshlrev_b32 v106, 16, v106
    v_cvt_pk_bf16_f32 v122, v122, v122
    v_lshlrev_b32 v122, 16, v122
    v_mul_f32 v23, s34, v106
    v_exp_f32 v23, v23
    s_nop 0
    v_add_f32 v23, 1.0, v23
    v_rcp_f32 v23, v23
    s_nop 0
    v_mul_f32 v23, v23, v106
    v_cvt_pk_bf16_f32 v23, v23, v23
    v_lshlrev_b32 v23, 16, v23
    v_mul_f32 v23, v23, v122
    v_cvt_pk_bf16_f32 v23, v23, v23
    v_add_u32 v24, 172800, v22
    buffer_store_short v23, v24, s[20:23], s33 offen
    v_cvt_pk_bf16_f32 v107, v107, v107
    v_lshlrev_b32 v107, 16, v107
    v_cvt_pk_bf16_f32 v123, v123, v123
    v_lshlrev_b32 v123, 16, v123
    v_mul_f32 v23, s34, v107
    v_exp_f32 v23, v23
    s_nop 0
    v_add_f32 v23, 1.0, v23
    v_rcp_f32 v23, v23
    s_nop 0
    v_mul_f32 v23, v23, v107
    v_cvt_pk_bf16_f32 v23, v23, v23
    v_lshlrev_b32 v23, 16, v23
    v_mul_f32 v23, v23, v123
    v_cvt_pk_bf16_f32 v23, v23, v23
    v_add_u32 v24, 176256, v22
    buffer_store_short v23, v24, s[20:23], s33 offen
    v_cvt_pk_bf16_f32 v108, v108, v108
    v_lshlrev_b32 v108, 16, v108
    v_cvt_pk_bf16_f32 v124, v124, v124
    v_lshlrev_b32 v124, 16, v124
    v_mul_f32 v23, s34, v108
    v_exp_f32 v23, v23
    s_nop 0
    v_add_f32 v23, 1.0, v23
    v_rcp_f32 v23, v23
    s_nop 0
    v_mul_f32 v23, v23, v108
    v_cvt_pk_bf16_f32 v23, v23, v23
    v_lshlrev_b32 v23, 16, v23
    v_mul_f32 v23, v23, v124
    v_cvt_pk_bf16_f32 v23, v23, v23
    v_add_u32 v24, 193536, v22
    buffer_store_short v23, v24, s[20:23], s33 offen
    v_cvt_pk_bf16_f32 v109, v109, v109
    v_lshlrev_b32 v109, 16, v109
    v_cvt_pk_bf16_f32 v125, v125, v125
    v_lshlrev_b32 v125, 16, v125
    v_mul_f32 v23, s34, v109
    v_exp_f32 v23, v23
    s_nop 0
    v_add_f32 v23, 1.0, v23
    v_rcp_f32 v23, v23
    s_nop 0
    v_mul_f32 v23, v23, v109
    v_cvt_pk_bf16_f32 v23, v23, v23
    v_lshlrev_b32 v23, 16, v23
    v_mul_f32 v23, v23, v125
    v_cvt_pk_bf16_f32 v23, v23, v23
    v_add_u32 v24, 196992, v22
    buffer_store_short v23, v24, s[20:23], s33 offen
    v_cvt_pk_bf16_f32 v110, v110, v110
    v_lshlrev_b32 v110, 16, v110
    v_cvt_pk_bf16_f32 v126, v126, v126
    v_lshlrev_b32 v126, 16, v126
    v_mul_f32 v23, s34, v110
    v_exp_f32 v23, v23
    s_nop 0
    v_add_f32 v23, 1.0, v23
    v_rcp_f32 v23, v23
    s_nop 0
    v_mul_f32 v23, v23, v110
    v_cvt_pk_bf16_f32 v23, v23, v23
    v_lshlrev_b32 v23, 16, v23
    v_mul_f32 v23, v23, v126
    v_cvt_pk_bf16_f32 v23, v23, v23
    v_add_u32 v24, 200448, v22
    buffer_store_short v23, v24, s[20:23], s33 offen
    v_cvt_pk_bf16_f32 v111, v111, v111
    v_lshlrev_b32 v111, 16, v111
    v_cvt_pk_bf16_f32 v127, v127, v127
    v_lshlrev_b32 v127, 16, v127
    v_mul_f32 v23, s34, v111
    v_exp_f32 v23, v23
    s_nop 0
    v_add_f32 v23, 1.0, v23
    v_rcp_f32 v23, v23
    s_nop 0
    v_mul_f32 v23, v23, v111
    v_cvt_pk_bf16_f32 v23, v23, v23
    v_lshlrev_b32 v23, 16, v23
    v_mul_f32 v23, v23, v127
    v_cvt_pk_bf16_f32 v23, v23, v23
    v_add_u32 v24, 203904, v22
    buffer_store_short v23, v24, s[20:23], s33 offen
    s_endpgm
.globl k5_kernel
.p2align 8
.type k5_kernel,@function
k5_kernel:
    s_cmp_lt_u32 s2, 320
    s_cbranch_scc1 G2_GO
    s_endpgm
G2_GO:
    s_load_dwordx2 s[4:5], s[0:1], 80
    s_load_dwordx2 s[6:7], s[0:1], 88
    s_load_dwordx2 s[10:11], s[0:1], 96
    s_load_dwordx2 s[8:9], s[0:1], 136
    s_load_dwordx2 s[36:37], s[0:1], 120
    s_waitcnt lgkmcnt(0)
    s_mov_b32 s20, s8
    s_and_b32 s21, s9, 0xffff
    s_mov_b32 s22, 268435456
    s_mov_b32 s23, 0x20000
    s_mov_b32 s12, s10
    s_and_b32 s13, s11, 0xffff
    s_mov_b32 s14, 2211840
    s_mov_b32 s15, 0x20000
    s_mov_b32 s16, s10
    s_and_b32 s17, s11, 0xffff
    s_mov_b32 s18, 2211840
    s_mov_b32 s19, 0x20000
    s_mov_b32 s40, s36
    s_and_b32 s41, s37, 0xffff
    s_mov_b32 s42, 2621440
    s_mov_b32 s43, 0x20000
    s_mov_b32 s24, 429496730
    s_lshr_b32 s38, s2, 3
    s_mul_hi_u32 s25, s38, s24
    s_mul_i32 s26, s25, 10
    s_sub_u32 s26, s38, s26
    s_and_b32 s39, s2, 7
    s_lshl_b32 s25, s25, 3
    s_add_u32 s25, s25, s39
    v_lshrrev_b32 v1, 3, v0
    v_and_b32 v2, 7, v0
    s_mul_i32 s27, s25, 64
    v_add_u32 v3, s27, v1
    s_movk_i32 s28, 3456
    v_mul_lo_u32 v3, v3, s28
    v_lshl_add_u32 v3, v2, 4, v3
    s_movk_i32 s28, 400
    v_mul_lo_u32 v4, v1, s28
    v_lshl_add_u32 v4, v2, 4, v4
    s_mov_b32 s29, 16777216
    s_movk_i32 s28, 1280
    v_mul_lo_u32 v5, v1, s28
    v_lshl_add_u32 v5, v2, 4, v5
    s_mul_i32 s30, s26, 128
    s_add_u32 s31, s30, 128
    s_movk_i32 s28, 192
    v_mul_lo_u32 v6, v1, s28
    v_lshl_add_u32 v6, v2, 4, v6
    v_lshrrev_b32 v7, 6, v0
    v_and_b32 v8, 63, v0
    v_lshrrev_b32 v9, 1, v7
    v_and_b32 v10, 1, v7
    v_and_b32 v11, 31, v8
    v_lshrrev_b32 v12, 5, v8
    v_mul_u32_u24 v13, 32, v9
    v_add_u32 v13, v13, v11
    s_movk_i32 s28, 400
    v_mul_lo_u32 v13, v13, s28
    v_lshl_add_u32 v13, v12, 4, v13
    v_lshrrev_b32 v14, 4, v8
    v_lshrrev_b32 v15, 1, v14
    v_lshlrev_b32 v15, 3, v15
    v_bfe_u32 v16, v8, 2, 2
    v_add_u32 v15, v15, v16
    s_movk_i32 s28, 192
    v_mul_lo_u32 v15, v15, s28
    v_and_b32 v16, 1, v14
    v_lshlrev_b32 v16, 5, v16
    v_lshl_add_u32 v16, v10, 6, v16
    v_and_b32 v17, 3, v8
    v_lshl_add_u32 v16, v17, 3, v16
    v_add_u32 v15, v15, v16
    v_add_u32 v15, 25600, v15
    v_mov_b32 v64, 0
    v_mov_b32 v65, 0
    v_mov_b32 v66, 0
    v_mov_b32 v67, 0
    v_mov_b32 v68, 0
    v_mov_b32 v69, 0
    v_mov_b32 v70, 0
    v_mov_b32 v71, 0
    v_mov_b32 v72, 0
    v_mov_b32 v73, 0
    v_mov_b32 v74, 0
    v_mov_b32 v75, 0
    v_mov_b32 v76, 0
    v_mov_b32 v77, 0
    v_mov_b32 v78, 0
    v_mov_b32 v79, 0
    v_mov_b32 v80, 0
    v_mov_b32 v81, 0
    v_mov_b32 v82, 0
    v_mov_b32 v83, 0
    v_mov_b32 v84, 0
    v_mov_b32 v85, 0
    v_mov_b32 v86, 0
    v_mov_b32 v87, 0
    v_mov_b32 v88, 0
    v_mov_b32 v89, 0
    v_mov_b32 v90, 0
    v_mov_b32 v91, 0
    v_mov_b32 v92, 0
    v_mov_b32 v93, 0
    v_mov_b32 v94, 0
    v_mov_b32 v95, 0
    v_add_u32 v18, 0, v3
    buffer_load_dwordx4 v[144:147], v18, s[20:23], s29 offen
    v_add_u32 v18, 128, v3
    buffer_load_dwordx4 v[148:151], v18, s[20:23], s29 offen
    v_add_u32 v18, 256, v3
    buffer_load_dwordx4 v[152:155], v18, s[20:23], s29 offen
    v_add_u32 v18, 110592, v3
    buffer_load_dwordx4 v[156:159], v18, s[20:23], s29 offen
    v_add_u32 v18, 110720, v3
    buffer_load_dwordx4 v[160:163], v18, s[20:23], s29 offen
    v_add_u32 v18, 110848, v3
    buffer_load_dwordx4 v[164:167], v18, s[20:23], s29 offen
    v_add_u32 v18, 0, v5
    buffer_load_dwordx4 v[168:171], v18, s[12:15], s30 offen
    v_add_u32 v18, 40960, v5
    buffer_load_dwordx4 v[172:175], v18, s[12:15], s30 offen
    v_add_u32 v18, 81920, v5
    buffer_load_dwordx4 v[176:179], v18, s[12:15], s30 offen
    v_add_u32 v18, 122880, v5
    buffer_load_dwordx4 v[180:183], v18, s[12:15], s30 offen
    v_add_u32 v18, 163840, v5
    buffer_load_dwordx4 v[184:187], v18, s[12:15], s30 offen
    v_add_u32 v18, 204800, v5
    buffer_load_dwordx4 v[188:191], v18, s[12:15], s30 offen
    v_add_u32 v3, 384, v3
    v_add_u32 v5, 245760, v5
    v_add_u32 v18, 0, v3
    buffer_load_dwordx4 v[192:195], v18, s[20:23], s29 offen
    v_add_u32 v18, 128, v3
    buffer_load_dwordx4 v[196:199], v18, s[20:23], s29 offen
    v_add_u32 v18, 256, v3
    buffer_load_dwordx4 v[200:203], v18, s[20:23], s29 offen
    v_add_u32 v18, 110592, v3
    buffer_load_dwordx4 v[204:207], v18, s[20:23], s29 offen
    v_add_u32 v18, 110720, v3
    buffer_load_dwordx4 v[208:211], v18, s[20:23], s29 offen
    v_add_u32 v18, 110848, v3
    buffer_load_dwordx4 v[212:215], v18, s[20:23], s29 offen
    v_add_u32 v18, 0, v5
    buffer_load_dwordx4 v[216:219], v18, s[12:15], s30 offen
    v_add_u32 v18, 40960, v5
    buffer_load_dwordx4 v[220:223], v18, s[12:15], s30 offen
    v_add_u32 v18, 81920, v5
    buffer_load_dwordx4 v[224:227], v18, s[12:15], s30 offen
    v_add_u32 v18, 122880, v5
    buffer_load_dwordx4 v[228:231], v18, s[12:15], s30 offen
    v_add_u32 v18, 163840, v5
    buffer_load_dwordx4 v[232:235], v18, s[12:15], s30 offen
    v_add_u32 v18, 204800, v5
    buffer_load_dwordx4 v[236:239], v18, s[12:15], s30 offen
    s_waitcnt vmcnt(12)
    ds_write_b128 v4, v[144:147] offset:0
    ds_write_b128 v4, v[148:151] offset:128
    ds_write_b128 v4, v[152:155] offset:256
    ds_write_b128 v4, v[156:159] offset:12800
    ds_write_b128 v4, v[160:163] offset:12928
    ds_write_b128 v4, v[164:167] offset:13056
    v_add_u32 v18, 25600, v6
    ds_write_b128 v18, v[168:171]
    v_add_u32 v18, 31744, v6
    ds_write_b128 v18, v[172:175]
    v_add_u32 v18, 37888, v6
    ds_write_b128 v18, v[176:179]
    v_add_u32 v18, 44032, v6
    ds_write_b128 v18, v[180:183]
    v_add_u32 v18, 50176, v6
    ds_write_b128 v18, v[184:187]
    v_add_u32 v18, 56320, v6
    ds_write_b128 v18, v[188:191]
    s_waitcnt lgkmcnt(0)
    s_barrier
    v_add_u32 v3, 384, v3
    v_add_u32 v5, 245760, v5
    v_add_u32 v18, 0, v3
    buffer_load_dwordx4 v[144:147], v18, s[20:23], s29 offen
    v_add_u32 v18, 128, v3
    buffer_load_dwordx4 v[148:151], v18, s[20:23], s29 offen
    v_add_u32 v18, 256, v3
    buffer_load_dwordx4 v[152:155], v18, s[20:23], s29 offen
    v_add_u32 v18, 110592, v3
    buffer_load_dwordx4 v[156:159], v18, s[20:23], s29 offen
    v_add_u32 v18, 110720, v3
    buffer_load_dwordx4 v[160:163], v18, s[20:23], s29 offen
    v_add_u32 v18, 110848, v3
    buffer_load_dwordx4 v[164:167], v18, s[20:23], s29 offen
    v_add_u32 v18, 0, v5
    buffer_load_dwordx4 v[168:171], v18, s[12:15], s30 offen
    v_add_u32 v18, 40960, v5
    buffer_load_dwordx4 v[172:175], v18, s[12:15], s30 offen
    v_add_u32 v18, 81920, v5
    buffer_load_dwordx4 v[176:179], v18, s[12:15], s30 offen
    v_add_u32 v18, 122880, v5
    buffer_load_dwordx4 v[180:183], v18, s[12:15], s30 offen
    v_add_u32 v18, 163840, v5
    buffer_load_dwordx4 v[184:187], v18, s[12:15], s30 offen
    v_add_u32 v18, 204800, v5
    buffer_load_dwordx4 v[188:191], v18, s[12:15], s30 offen
    ds_read_b128 v[128:131], v13 offset:0
    ds_read_b64_tr_b16 v[132:133], v15 offset:0
    ds_read_b64_tr_b16 v[134:135], v15 offset:768
    ds_read_b128 v[136:139], v13 offset:32
    ds_read_b64_tr_b16 v[140:141], v15 offset:3072
    ds_read_b64_tr_b16 v[142:143], v15 offset:3840
    ds_read_b128 v[240:243], v13 offset:64
    ds_read_b64_tr_b16 v[244:245], v15 offset:6144
    ds_read_b64_tr_b16 v[246:247], v15 offset:6912
    ds_read_b128 v[248:251], v13 offset:96
    ds_read_b64_tr_b16 v[252:253], v15 offset:9216
    ds_read_b64_tr_b16 v[254:255], v15 offset:9984
    s_waitcnt lgkmcnt(9)
    v_mfma_f32_32x32x16_bf16 v[64:79], v[128:131], v[132:135], v[64:79]
    ds_read_b128 v[128:131], v13 offset:128
    ds_read_b64_tr_b16 v[132:133], v15 offset:12288
    ds_read_b64_tr_b16 v[134:135], v15 offset:13056
    s_waitcnt lgkmcnt(9)
    v_mfma_f32_32x32x16_bf16 v[64:79], v[136:139], v[140:143], v[64:79]
    ds_read_b128 v[136:139], v13 offset:160
    ds_read_b64_tr_b16 v[140:141], v15 offset:15360
    ds_read_b64_tr_b16 v[142:143], v15 offset:16128
    s_waitcnt lgkmcnt(9)
    v_mfma_f32_32x32x16_bf16 v[64:79], v[240:243], v[244:247], v[64:79]
    ds_read_b128 v[240:243], v13 offset:192
    ds_read_b64_tr_b16 v[244:245], v15 offset:18432
    ds_read_b64_tr_b16 v[246:247], v15 offset:19200
    s_waitcnt lgkmcnt(9)
    v_mfma_f32_32x32x16_bf16 v[64:79], v[248:251], v[252:255], v[64:79]
    ds_read_b128 v[248:251], v13 offset:224
    ds_read_b64_tr_b16 v[252:253], v15 offset:21504
    ds_read_b64_tr_b16 v[254:255], v15 offset:22272
    s_waitcnt lgkmcnt(9)
    v_mfma_f32_32x32x16_bf16 v[64:79], v[128:131], v[132:135], v[64:79]
    ds_read_b128 v[128:131], v13 offset:256
    ds_read_b64_tr_b16 v[132:133], v15 offset:24576
    ds_read_b64_tr_b16 v[134:135], v15 offset:25344
    s_waitcnt lgkmcnt(9)
    v_mfma_f32_32x32x16_bf16 v[64:79], v[136:139], v[140:143], v[64:79]
    ds_read_b128 v[136:139], v13 offset:288
    ds_read_b64_tr_b16 v[140:141], v15 offset:27648
    ds_read_b64_tr_b16 v[142:143], v15 offset:28416
    s_waitcnt lgkmcnt(9)
    v_mfma_f32_32x32x16_bf16 v[64:79], v[240:243], v[244:247], v[64:79]
    ds_read_b128 v[240:243], v13 offset:320
    ds_read_b64_tr_b16 v[244:245], v15 offset:30720
    ds_read_b64_tr_b16 v[246:247], v15 offset:31488
    s_waitcnt lgkmcnt(9)
    v_mfma_f32_32x32x16_bf16 v[64:79], v[248:251], v[252:255], v[64:79]
    ds_read_b128 v[248:251], v13 offset:352
    ds_read_b64_tr_b16 v[252:253], v15 offset:33792
    ds_read_b64_tr_b16 v[254:255], v15 offset:34560
    s_waitcnt lgkmcnt(9)
    v_mfma_f32_32x32x16_bf16 v[64:79], v[128:131], v[132:135], v[64:79]
    s_waitcnt lgkmcnt(6)
    v_mfma_f32_32x32x16_bf16 v[64:79], v[136:139], v[140:143], v[64:79]
    s_waitcnt lgkmcnt(3)
    v_mfma_f32_32x32x16_bf16 v[64:79], v[240:243], v[244:247], v[64:79]
    s_waitcnt lgkmcnt(0)
    v_mfma_f32_32x32x16_bf16 v[64:79], v[248:251], v[252:255], v[64:79]
    s_barrier
    s_waitcnt vmcnt(12)
    ds_write_b128 v4, v[192:195] offset:0
    ds_write_b128 v4, v[196:199] offset:128
    ds_write_b128 v4, v[200:203] offset:256
    ds_write_b128 v4, v[204:207] offset:12800
    ds_write_b128 v4, v[208:211] offset:12928
    ds_write_b128 v4, v[212:215] offset:13056
    v_add_u32 v18, 25600, v6
    ds_write_b128 v18, v[216:219]
    v_add_u32 v18, 31744, v6
    ds_write_b128 v18, v[220:223]
    v_add_u32 v18, 37888, v6
    ds_write_b128 v18, v[224:227]
    v_add_u32 v18, 44032, v6
    ds_write_b128 v18, v[228:231]
    v_add_u32 v18, 50176, v6
    ds_write_b128 v18, v[232:235]
    v_add_u32 v18, 56320, v6
    ds_write_b128 v18, v[236:239]
    s_waitcnt lgkmcnt(0)
    s_barrier
    v_add_u32 v3, 384, v3
    v_add_u32 v5, 245760, v5
    v_add_u32 v18, 0, v3
    buffer_load_dwordx4 v[192:195], v18, s[20:23], s29 offen
    v_add_u32 v18, 128, v3
    buffer_load_dwordx4 v[196:199], v18, s[20:23], s29 offen
    v_add_u32 v18, 256, v3
    buffer_load_dwordx4 v[200:203], v18, s[20:23], s29 offen
    v_add_u32 v18, 110592, v3
    buffer_load_dwordx4 v[204:207], v18, s[20:23], s29 offen
    v_add_u32 v18, 110720, v3
    buffer_load_dwordx4 v[208:211], v18, s[20:23], s29 offen
    v_add_u32 v18, 110848, v3
    buffer_load_dwordx4 v[212:215], v18, s[20:23], s29 offen
    v_add_u32 v18, 0, v5
    buffer_load_dwordx4 v[216:219], v18, s[12:15], s30 offen
    v_add_u32 v18, 40960, v5
    buffer_load_dwordx4 v[220:223], v18, s[12:15], s30 offen
    v_add_u32 v18, 81920, v5
    buffer_load_dwordx4 v[224:227], v18, s[12:15], s30 offen
    v_add_u32 v18, 122880, v5
    buffer_load_dwordx4 v[228:231], v18, s[12:15], s30 offen
    v_add_u32 v18, 163840, v5
    buffer_load_dwordx4 v[232:235], v18, s[12:15], s30 offen
    v_add_u32 v18, 204800, v5
    buffer_load_dwordx4 v[236:239], v18, s[12:15], s30 offen
    ds_read_b128 v[128:131], v13 offset:0
    ds_read_b64_tr_b16 v[132:133], v15 offset:0
    ds_read_b64_tr_b16 v[134:135], v15 offset:768
    ds_read_b128 v[136:139], v13 offset:32
    ds_read_b64_tr_b16 v[140:141], v15 offset:3072
    ds_read_b64_tr_b16 v[142:143], v15 offset:3840
    ds_read_b128 v[240:243], v13 offset:64
    ds_read_b64_tr_b16 v[244:245], v15 offset:6144
    ds_read_b64_tr_b16 v[246:247], v15 offset:6912
    ds_read_b128 v[248:251], v13 offset:96
    ds_read_b64_tr_b16 v[252:253], v15 offset:9216
    ds_read_b64_tr_b16 v[254:255], v15 offset:9984
    s_waitcnt lgkmcnt(9)
    v_mfma_f32_32x32x16_bf16 v[64:79], v[128:131], v[132:135], v[64:79]
    ds_read_b128 v[128:131], v13 offset:128
    ds_read_b64_tr_b16 v[132:133], v15 offset:12288
    ds_read_b64_tr_b16 v[134:135], v15 offset:13056
    s_waitcnt lgkmcnt(9)
    v_mfma_f32_32x32x16_bf16 v[64:79], v[136:139], v[140:143], v[64:79]
    ds_read_b128 v[136:139], v13 offset:160
    ds_read_b64_tr_b16 v[140:141], v15 offset:15360
    ds_read_b64_tr_b16 v[142:143], v15 offset:16128
    s_waitcnt lgkmcnt(9)
    v_mfma_f32_32x32x16_bf16 v[64:79], v[240:243], v[244:247], v[64:79]
    ds_read_b128 v[240:243], v13 offset:192
    ds_read_b64_tr_b16 v[244:245], v15 offset:18432
    ds_read_b64_tr_b16 v[246:247], v15 offset:19200
    s_waitcnt lgkmcnt(9)
    v_mfma_f32_32x32x16_bf16 v[64:79], v[248:251], v[252:255], v[64:79]
    ds_read_b128 v[248:251], v13 offset:224
    ds_read_b64_tr_b16 v[252:253], v15 offset:21504
    ds_read_b64_tr_b16 v[254:255], v15 offset:22272
    s_waitcnt lgkmcnt(9)
    v_mfma_f32_32x32x16_bf16 v[64:79], v[128:131], v[132:135], v[64:79]
    ds_read_b128 v[128:131], v13 offset:256
    ds_read_b64_tr_b16 v[132:133], v15 offset:24576
    ds_read_b64_tr_b16 v[134:135], v15 offset:25344
    s_waitcnt lgkmcnt(9)
    v_mfma_f32_32x32x16_bf16 v[64:79], v[136:139], v[140:143], v[64:79]
    ds_read_b128 v[136:139], v13 offset:288
    ds_read_b64_tr_b16 v[140:141], v15 offset:27648
    ds_read_b64_tr_b16 v[142:143], v15 offset:28416
    s_waitcnt lgkmcnt(9)
    v_mfma_f32_32x32x16_bf16 v[64:79], v[240:243], v[244:247], v[64:79]
    ds_read_b128 v[240:243], v13 offset:320
    ds_read_b64_tr_b16 v[244:245], v15 offset:30720
    ds_read_b64_tr_b16 v[246:247], v15 offset:31488
    s_waitcnt lgkmcnt(9)
    v_mfma_f32_32x32x16_bf16 v[64:79], v[248:251], v[252:255], v[64:79]
    ds_read_b128 v[248:251], v13 offset:352
    ds_read_b64_tr_b16 v[252:253], v15 offset:33792
    ds_read_b64_tr_b16 v[254:255], v15 offset:34560
    s_waitcnt lgkmcnt(9)
    v_mfma_f32_32x32x16_bf16 v[64:79], v[128:131], v[132:135], v[64:79]
    s_waitcnt lgkmcnt(6)
    v_mfma_f32_32x32x16_bf16 v[64:79], v[136:139], v[140:143], v[64:79]
    s_waitcnt lgkmcnt(3)
    v_mfma_f32_32x32x16_bf16 v[64:79], v[240:243], v[244:247], v[64:79]
    s_waitcnt lgkmcnt(0)
    v_mfma_f32_32x32x16_bf16 v[64:79], v[248:251], v[252:255], v[64:79]
    s_barrier
    s_waitcnt vmcnt(12)
    ds_write_b128 v4, v[144:147] offset:0
    ds_write_b128 v4, v[148:151] offset:128
    ds_write_b128 v4, v[152:155] offset:256
    ds_write_b128 v4, v[156:159] offset:12800
    ds_write_b128 v4, v[160:163] offset:12928
    ds_write_b128 v4, v[164:167] offset:13056
    v_add_u32 v18, 25600, v6
    ds_write_b128 v18, v[168:171]
    v_add_u32 v18, 31744, v6
    ds_write_b128 v18, v[172:175]
    v_add_u32 v18, 37888, v6
    ds_write_b128 v18, v[176:179]
    v_add_u32 v18, 44032, v6
    ds_write_b128 v18, v[180:183]
    v_add_u32 v18, 50176, v6
    ds_write_b128 v18, v[184:187]
    v_add_u32 v18, 56320, v6
    ds_write_b128 v18, v[188:191]
    s_waitcnt lgkmcnt(0)
    s_barrier
    v_add_u32 v3, 384, v3
    v_add_u32 v5, 245760, v5
    v_add_u32 v18, 0, v3
    buffer_load_dwordx4 v[144:147], v18, s[20:23], s29 offen
    v_add_u32 v18, 128, v3
    buffer_load_dwordx4 v[148:151], v18, s[20:23], s29 offen
    v_add_u32 v18, 256, v3
    buffer_load_dwordx4 v[152:155], v18, s[20:23], s29 offen
    v_add_u32 v18, 110592, v3
    buffer_load_dwordx4 v[156:159], v18, s[20:23], s29 offen
    v_add_u32 v18, 110720, v3
    buffer_load_dwordx4 v[160:163], v18, s[20:23], s29 offen
    v_add_u32 v18, 110848, v3
    buffer_load_dwordx4 v[164:167], v18, s[20:23], s29 offen
    v_add_u32 v18, 0, v5
    buffer_load_dwordx4 v[168:171], v18, s[12:15], s30 offen
    v_add_u32 v18, 40960, v5
    buffer_load_dwordx4 v[172:175], v18, s[12:15], s30 offen
    v_add_u32 v18, 81920, v5
    buffer_load_dwordx4 v[176:179], v18, s[12:15], s30 offen
    v_add_u32 v18, 122880, v5
    buffer_load_dwordx4 v[180:183], v18, s[12:15], s30 offen
    v_add_u32 v18, 163840, v5
    buffer_load_dwordx4 v[184:187], v18, s[12:15], s30 offen
    v_add_u32 v18, 204800, v5
    buffer_load_dwordx4 v[188:191], v18, s[12:15], s30 offen
    ds_read_b128 v[128:131], v13 offset:0
    ds_read_b64_tr_b16 v[132:133], v15 offset:0
    ds_read_b64_tr_b16 v[134:135], v15 offset:768
    ds_read_b128 v[136:139], v13 offset:32
    ds_read_b64_tr_b16 v[140:141], v15 offset:3072
    ds_read_b64_tr_b16 v[142:143], v15 offset:3840
    ds_read_b128 v[240:243], v13 offset:64
    ds_read_b64_tr_b16 v[244:245], v15 offset:6144
    ds_read_b64_tr_b16 v[246:247], v15 offset:6912
    ds_read_b128 v[248:251], v13 offset:96
    ds_read_b64_tr_b16 v[252:253], v15 offset:9216
    ds_read_b64_tr_b16 v[254:255], v15 offset:9984
    s_waitcnt lgkmcnt(9)
    v_mfma_f32_32x32x16_bf16 v[64:79], v[128:131], v[132:135], v[64:79]
    ds_read_b128 v[128:131], v13 offset:128
    ds_read_b64_tr_b16 v[132:133], v15 offset:12288
    ds_read_b64_tr_b16 v[134:135], v15 offset:13056
    s_waitcnt lgkmcnt(9)
    v_mfma_f32_32x32x16_bf16 v[64:79], v[136:139], v[140:143], v[64:79]
    ds_read_b128 v[136:139], v13 offset:160
    ds_read_b64_tr_b16 v[140:141], v15 offset:15360
    ds_read_b64_tr_b16 v[142:143], v15 offset:16128
    s_waitcnt lgkmcnt(9)
    v_mfma_f32_32x32x16_bf16 v[64:79], v[240:243], v[244:247], v[64:79]
    ds_read_b128 v[240:243], v13 offset:192
    ds_read_b64_tr_b16 v[244:245], v15 offset:18432
    ds_read_b64_tr_b16 v[246:247], v15 offset:19200
    s_waitcnt lgkmcnt(9)
    v_mfma_f32_32x32x16_bf16 v[64:79], v[248:251], v[252:255], v[64:79]
    ds_read_b128 v[248:251], v13 offset:224
    ds_read_b64_tr_b16 v[252:253], v15 offset:21504
    ds_read_b64_tr_b16 v[254:255], v15 offset:22272
    s_waitcnt lgkmcnt(9)
    v_mfma_f32_32x32x16_bf16 v[64:79], v[128:131], v[132:135], v[64:79]
    ds_read_b128 v[128:131], v13 offset:256
    ds_read_b64_tr_b16 v[132:133], v15 offset:24576
    ds_read_b64_tr_b16 v[134:135], v15 offset:25344
    s_waitcnt lgkmcnt(9)
    v_mfma_f32_32x32x16_bf16 v[64:79], v[136:139], v[140:143], v[64:79]
    ds_read_b128 v[136:139], v13 offset:288
    ds_read_b64_tr_b16 v[140:141], v15 offset:27648
    ds_read_b64_tr_b16 v[142:143], v15 offset:28416
    s_waitcnt lgkmcnt(9)
    v_mfma_f32_32x32x16_bf16 v[64:79], v[240:243], v[244:247], v[64:79]
    ds_read_b128 v[240:243], v13 offset:320
    ds_read_b64_tr_b16 v[244:245], v15 offset:30720
    ds_read_b64_tr_b16 v[246:247], v15 offset:31488
    s_waitcnt lgkmcnt(9)
    v_mfma_f32_32x32x16_bf16 v[64:79], v[248:251], v[252:255], v[64:79]
    ds_read_b128 v[248:251], v13 offset:352
    ds_read_b64_tr_b16 v[252:253], v15 offset:33792
    ds_read_b64_tr_b16 v[254:255], v15 offset:34560
    s_waitcnt lgkmcnt(9)
    v_mfma_f32_32x32x16_bf16 v[64:79], v[128:131], v[132:135], v[64:79]
    s_waitcnt lgkmcnt(6)
    v_mfma_f32_32x32x16_bf16 v[64:79], v[136:139], v[140:143], v[64:79]
    s_waitcnt lgkmcnt(3)
    v_mfma_f32_32x32x16_bf16 v[64:79], v[240:243], v[244:247], v[64:79]
    s_waitcnt lgkmcnt(0)
    v_mfma_f32_32x32x16_bf16 v[64:79], v[248:251], v[252:255], v[64:79]
    s_barrier
    s_waitcnt vmcnt(12)
    ds_write_b128 v4, v[192:195] offset:0
    ds_write_b128 v4, v[196:199] offset:128
    ds_write_b128 v4, v[200:203] offset:256
    ds_write_b128 v4, v[204:207] offset:12800
    ds_write_b128 v4, v[208:211] offset:12928
    ds_write_b128 v4, v[212:215] offset:13056
    v_add_u32 v18, 25600, v6
    ds_write_b128 v18, v[216:219]
    v_add_u32 v18, 31744, v6
    ds_write_b128 v18, v[220:223]
    v_add_u32 v18, 37888, v6
    ds_write_b128 v18, v[224:227]
    v_add_u32 v18, 44032, v6
    ds_write_b128 v18, v[228:231]
    v_add_u32 v18, 50176, v6
    ds_write_b128 v18, v[232:235]
    v_add_u32 v18, 56320, v6
    ds_write_b128 v18, v[236:239]
    s_waitcnt lgkmcnt(0)
    s_barrier
    v_add_u32 v3, 384, v3
    v_add_u32 v5, 245760, v5
    v_add_u32 v18, 0, v3
    buffer_load_dwordx4 v[192:195], v18, s[20:23], s29 offen
    v_add_u32 v18, 128, v3
    buffer_load_dwordx4 v[196:199], v18, s[20:23], s29 offen
    v_add_u32 v18, 256, v3
    buffer_load_dwordx4 v[200:203], v18, s[20:23], s29 offen
    v_add_u32 v18, 110592, v3
    buffer_load_dwordx4 v[204:207], v18, s[20:23], s29 offen
    v_add_u32 v18, 110720, v3
    buffer_load_dwordx4 v[208:211], v18, s[20:23], s29 offen
    v_add_u32 v18, 110848, v3
    buffer_load_dwordx4 v[212:215], v18, s[20:23], s29 offen
    v_add_u32 v18, 0, v5
    buffer_load_dwordx4 v[216:219], v18, s[12:15], s30 offen
    v_add_u32 v18, 40960, v5
    buffer_load_dwordx4 v[220:223], v18, s[12:15], s30 offen
    v_add_u32 v18, 81920, v5
    buffer_load_dwordx4 v[224:227], v18, s[12:15], s30 offen
    v_add_u32 v18, 122880, v5
    buffer_load_dwordx4 v[228:231], v18, s[12:15], s30 offen
    v_add_u32 v18, 163840, v5
    buffer_load_dwordx4 v[232:235], v18, s[12:15], s30 offen
    v_add_u32 v18, 204800, v5
    buffer_load_dwordx4 v[236:239], v18, s[12:15], s30 offen
    ds_read_b128 v[128:131], v13 offset:0
    ds_read_b64_tr_b16 v[132:133], v15 offset:0
    ds_read_b64_tr_b16 v[134:135], v15 offset:768
    ds_read_b128 v[136:139], v13 offset:32
    ds_read_b64_tr_b16 v[140:141], v15 offset:3072
    ds_read_b64_tr_b16 v[142:143], v15 offset:3840
    ds_read_b128 v[240:243], v13 offset:64
    ds_read_b64_tr_b16 v[244:245], v15 offset:6144
    ds_read_b64_tr_b16 v[246:247], v15 offset:6912
    ds_read_b128 v[248:251], v13 offset:96
    ds_read_b64_tr_b16 v[252:253], v15 offset:9216
    ds_read_b64_tr_b16 v[254:255], v15 offset:9984
    s_waitcnt lgkmcnt(9)
    v_mfma_f32_32x32x16_bf16 v[64:79], v[128:131], v[132:135], v[64:79]
    ds_read_b128 v[128:131], v13 offset:128
    ds_read_b64_tr_b16 v[132:133], v15 offset:12288
    ds_read_b64_tr_b16 v[134:135], v15 offset:13056
    s_waitcnt lgkmcnt(9)
    v_mfma_f32_32x32x16_bf16 v[64:79], v[136:139], v[140:143], v[64:79]
    ds_read_b128 v[136:139], v13 offset:160
    ds_read_b64_tr_b16 v[140:141], v15 offset:15360
    ds_read_b64_tr_b16 v[142:143], v15 offset:16128
    s_waitcnt lgkmcnt(9)
    v_mfma_f32_32x32x16_bf16 v[64:79], v[240:243], v[244:247], v[64:79]
    ds_read_b128 v[240:243], v13 offset:192
    ds_read_b64_tr_b16 v[244:245], v15 offset:18432
    ds_read_b64_tr_b16 v[246:247], v15 offset:19200
    s_waitcnt lgkmcnt(9)
    v_mfma_f32_32x32x16_bf16 v[64:79], v[248:251], v[252:255], v[64:79]
    ds_read_b128 v[248:251], v13 offset:224
    ds_read_b64_tr_b16 v[252:253], v15 offset:21504
    ds_read_b64_tr_b16 v[254:255], v15 offset:22272
    s_waitcnt lgkmcnt(9)
    v_mfma_f32_32x32x16_bf16 v[64:79], v[128:131], v[132:135], v[64:79]
    ds_read_b128 v[128:131], v13 offset:256
    ds_read_b64_tr_b16 v[132:133], v15 offset:24576
    ds_read_b64_tr_b16 v[134:135], v15 offset:25344
    s_waitcnt lgkmcnt(9)
    v_mfma_f32_32x32x16_bf16 v[64:79], v[136:139], v[140:143], v[64:79]
    ds_read_b128 v[136:139], v13 offset:288
    ds_read_b64_tr_b16 v[140:141], v15 offset:27648
    ds_read_b64_tr_b16 v[142:143], v15 offset:28416
    s_waitcnt lgkmcnt(9)
    v_mfma_f32_32x32x16_bf16 v[64:79], v[240:243], v[244:247], v[64:79]
    ds_read_b128 v[240:243], v13 offset:320
    ds_read_b64_tr_b16 v[244:245], v15 offset:30720
    ds_read_b64_tr_b16 v[246:247], v15 offset:31488
    s_waitcnt lgkmcnt(9)
    v_mfma_f32_32x32x16_bf16 v[64:79], v[248:251], v[252:255], v[64:79]
    ds_read_b128 v[248:251], v13 offset:352
    ds_read_b64_tr_b16 v[252:253], v15 offset:33792
    ds_read_b64_tr_b16 v[254:255], v15 offset:34560
    s_waitcnt lgkmcnt(9)
    v_mfma_f32_32x32x16_bf16 v[64:79], v[128:131], v[132:135], v[64:79]
    s_waitcnt lgkmcnt(6)
    v_mfma_f32_32x32x16_bf16 v[64:79], v[136:139], v[140:143], v[64:79]
    s_waitcnt lgkmcnt(3)
    v_mfma_f32_32x32x16_bf16 v[64:79], v[240:243], v[244:247], v[64:79]
    s_waitcnt lgkmcnt(0)
    v_mfma_f32_32x32x16_bf16 v[64:79], v[248:251], v[252:255], v[64:79]
    s_barrier
    s_waitcnt vmcnt(12)
    ds_write_b128 v4, v[144:147] offset:0
    ds_write_b128 v4, v[148:151] offset:128
    ds_write_b128 v4, v[152:155] offset:256
    ds_write_b128 v4, v[156:159] offset:12800
    ds_write_b128 v4, v[160:163] offset:12928
    ds_write_b128 v4, v[164:167] offset:13056
    v_add_u32 v18, 25600, v6
    ds_write_b128 v18, v[168:171]
    v_add_u32 v18, 31744, v6
    ds_write_b128 v18, v[172:175]
    v_add_u32 v18, 37888, v6
    ds_write_b128 v18, v[176:179]
    v_add_u32 v18, 44032, v6
    ds_write_b128 v18, v[180:183]
    v_add_u32 v18, 50176, v6
    ds_write_b128 v18, v[184:187]
    v_add_u32 v18, 56320, v6
    ds_write_b128 v18, v[188:191]
    s_waitcnt lgkmcnt(0)
    s_barrier
    v_add_u32 v3, 384, v3
    v_add_u32 v5, 245760, v5
    v_add_u32 v18, 0, v3
    buffer_load_dwordx4 v[144:147], v18, s[20:23], s29 offen
    v_add_u32 v18, 128, v3
    buffer_load_dwordx4 v[148:151], v18, s[20:23], s29 offen
    v_add_u32 v18, 256, v3
    buffer_load_dwordx4 v[152:155], v18, s[20:23], s29 offen
    v_add_u32 v18, 110592, v3
    buffer_load_dwordx4 v[156:159], v18, s[20:23], s29 offen
    v_add_u32 v18, 110720, v3
    buffer_load_dwordx4 v[160:163], v18, s[20:23], s29 offen
    v_add_u32 v18, 110848, v3
    buffer_load_dwordx4 v[164:167], v18, s[20:23], s29 offen
    v_add_u32 v18, 0, v5
    buffer_load_dwordx4 v[168:171], v18, s[12:15], s30 offen
    v_add_u32 v18, 40960, v5
    buffer_load_dwordx4 v[172:175], v18, s[12:15], s30 offen
    v_add_u32 v18, 81920, v5
    buffer_load_dwordx4 v[176:179], v18, s[12:15], s30 offen
    v_add_u32 v18, 122880, v5
    buffer_load_dwordx4 v[180:183], v18, s[12:15], s30 offen
    v_add_u32 v18, 163840, v5
    buffer_load_dwordx4 v[184:187], v18, s[12:15], s30 offen
    v_add_u32 v18, 204800, v5
    buffer_load_dwordx4 v[188:191], v18, s[12:15], s30 offen
    ds_read_b128 v[128:131], v13 offset:0
    ds_read_b64_tr_b16 v[132:133], v15 offset:0
    ds_read_b64_tr_b16 v[134:135], v15 offset:768
    ds_read_b128 v[136:139], v13 offset:32
    ds_read_b64_tr_b16 v[140:141], v15 offset:3072
    ds_read_b64_tr_b16 v[142:143], v15 offset:3840
    ds_read_b128 v[240:243], v13 offset:64
    ds_read_b64_tr_b16 v[244:245], v15 offset:6144
    ds_read_b64_tr_b16 v[246:247], v15 offset:6912
    ds_read_b128 v[248:251], v13 offset:96
    ds_read_b64_tr_b16 v[252:253], v15 offset:9216
    ds_read_b64_tr_b16 v[254:255], v15 offset:9984
    s_waitcnt lgkmcnt(9)
    v_mfma_f32_32x32x16_bf16 v[64:79], v[128:131], v[132:135], v[64:79]
    ds_read_b128 v[128:131], v13 offset:128
    ds_read_b64_tr_b16 v[132:133], v15 offset:12288
    ds_read_b64_tr_b16 v[134:135], v15 offset:13056
    s_waitcnt lgkmcnt(9)
    v_mfma_f32_32x32x16_bf16 v[64:79], v[136:139], v[140:143], v[64:79]
    ds_read_b128 v[136:139], v13 offset:160
    ds_read_b64_tr_b16 v[140:141], v15 offset:15360
    ds_read_b64_tr_b16 v[142:143], v15 offset:16128
    s_waitcnt lgkmcnt(9)
    v_mfma_f32_32x32x16_bf16 v[64:79], v[240:243], v[244:247], v[64:79]
    ds_read_b128 v[240:243], v13 offset:192
    ds_read_b64_tr_b16 v[244:245], v15 offset:18432
    ds_read_b64_tr_b16 v[246:247], v15 offset:19200
    s_waitcnt lgkmcnt(9)
    v_mfma_f32_32x32x16_bf16 v[64:79], v[248:251], v[252:255], v[64:79]
    ds_read_b128 v[248:251], v13 offset:224
    ds_read_b64_tr_b16 v[252:253], v15 offset:21504
    ds_read_b64_tr_b16 v[254:255], v15 offset:22272
    s_waitcnt lgkmcnt(9)
    v_mfma_f32_32x32x16_bf16 v[64:79], v[128:131], v[132:135], v[64:79]
    ds_read_b128 v[128:131], v13 offset:256
    ds_read_b64_tr_b16 v[132:133], v15 offset:24576
    ds_read_b64_tr_b16 v[134:135], v15 offset:25344
    s_waitcnt lgkmcnt(9)
    v_mfma_f32_32x32x16_bf16 v[64:79], v[136:139], v[140:143], v[64:79]
    ds_read_b128 v[136:139], v13 offset:288
    ds_read_b64_tr_b16 v[140:141], v15 offset:27648
    ds_read_b64_tr_b16 v[142:143], v15 offset:28416
    s_waitcnt lgkmcnt(9)
    v_mfma_f32_32x32x16_bf16 v[64:79], v[240:243], v[244:247], v[64:79]
    ds_read_b128 v[240:243], v13 offset:320
    ds_read_b64_tr_b16 v[244:245], v15 offset:30720
    ds_read_b64_tr_b16 v[246:247], v15 offset:31488
    s_waitcnt lgkmcnt(9)
    v_mfma_f32_32x32x16_bf16 v[64:79], v[248:251], v[252:255], v[64:79]
    ds_read_b128 v[248:251], v13 offset:352
    ds_read_b64_tr_b16 v[252:253], v15 offset:33792
    ds_read_b64_tr_b16 v[254:255], v15 offset:34560
    s_waitcnt lgkmcnt(9)
    v_mfma_f32_32x32x16_bf16 v[64:79], v[128:131], v[132:135], v[64:79]
    s_waitcnt lgkmcnt(6)
    v_mfma_f32_32x32x16_bf16 v[64:79], v[136:139], v[140:143], v[64:79]
    s_waitcnt lgkmcnt(3)
    v_mfma_f32_32x32x16_bf16 v[64:79], v[240:243], v[244:247], v[64:79]
    s_waitcnt lgkmcnt(0)
    v_mfma_f32_32x32x16_bf16 v[64:79], v[248:251], v[252:255], v[64:79]
    s_barrier
    s_waitcnt vmcnt(12)
    ds_write_b128 v4, v[192:195] offset:0
    ds_write_b128 v4, v[196:199] offset:128
    ds_write_b128 v4, v[200:203] offset:256
    ds_write_b128 v4, v[204:207] offset:12800
    ds_write_b128 v4, v[208:211] offset:12928
    ds_write_b128 v4, v[212:215] offset:13056
    v_add_u32 v18, 25600, v6
    ds_write_b128 v18, v[216:219]
    v_add_u32 v18, 31744, v6
    ds_write_b128 v18, v[220:223]
    v_add_u32 v18, 37888, v6
    ds_write_b128 v18, v[224:227]
    v_add_u32 v18, 44032, v6
    ds_write_b128 v18, v[228:231]
    v_add_u32 v18, 50176, v6
    ds_write_b128 v18, v[232:235]
    v_add_u32 v18, 56320, v6
    ds_write_b128 v18, v[236:239]
    s_waitcnt lgkmcnt(0)
    s_barrier
    v_add_u32 v3, 384, v3
    v_add_u32 v5, 245760, v5
    v_add_u32 v18, 0, v3
    buffer_load_dwordx4 v[192:195], v18, s[20:23], s29 offen
    v_add_u32 v18, 128, v3
    buffer_load_dwordx4 v[196:199], v18, s[20:23], s29 offen
    v_add_u32 v18, 256, v3
    buffer_load_dwordx4 v[200:203], v18, s[20:23], s29 offen
    v_add_u32 v18, 110592, v3
    buffer_load_dwordx4 v[204:207], v18, s[20:23], s29 offen
    v_add_u32 v18, 110720, v3
    buffer_load_dwordx4 v[208:211], v18, s[20:23], s29 offen
    v_add_u32 v18, 110848, v3
    buffer_load_dwordx4 v[212:215], v18, s[20:23], s29 offen
    v_add_u32 v18, 0, v5
    buffer_load_dwordx4 v[216:219], v18, s[12:15], s30 offen
    v_add_u32 v18, 40960, v5
    buffer_load_dwordx4 v[220:223], v18, s[12:15], s30 offen
    v_add_u32 v18, 81920, v5
    buffer_load_dwordx4 v[224:227], v18, s[12:15], s30 offen
    v_add_u32 v18, 122880, v5
    buffer_load_dwordx4 v[228:231], v18, s[12:15], s30 offen
    v_add_u32 v18, 163840, v5
    buffer_load_dwordx4 v[232:235], v18, s[12:15], s30 offen
    v_add_u32 v18, 204800, v5
    buffer_load_dwordx4 v[236:239], v18, s[12:15], s30 offen
    ds_read_b128 v[128:131], v13 offset:0
    ds_read_b64_tr_b16 v[132:133], v15 offset:0
    ds_read_b64_tr_b16 v[134:135], v15 offset:768
    ds_read_b128 v[136:139], v13 offset:32
    ds_read_b64_tr_b16 v[140:141], v15 offset:3072
    ds_read_b64_tr_b16 v[142:143], v15 offset:3840
    ds_read_b128 v[240:243], v13 offset:64
    ds_read_b64_tr_b16 v[244:245], v15 offset:6144
    ds_read_b64_tr_b16 v[246:247], v15 offset:6912
    ds_read_b128 v[248:251], v13 offset:96
    ds_read_b64_tr_b16 v[252:253], v15 offset:9216
    ds_read_b64_tr_b16 v[254:255], v15 offset:9984
    s_waitcnt lgkmcnt(9)
    v_mfma_f32_32x32x16_bf16 v[64:79], v[128:131], v[132:135], v[64:79]
    ds_read_b128 v[128:131], v13 offset:128
    ds_read_b64_tr_b16 v[132:133], v15 offset:12288
    ds_read_b64_tr_b16 v[134:135], v15 offset:13056
    s_waitcnt lgkmcnt(9)
    v_mfma_f32_32x32x16_bf16 v[64:79], v[136:139], v[140:143], v[64:79]
    ds_read_b128 v[136:139], v13 offset:160
    ds_read_b64_tr_b16 v[140:141], v15 offset:15360
    ds_read_b64_tr_b16 v[142:143], v15 offset:16128
    s_waitcnt lgkmcnt(9)
    v_mfma_f32_32x32x16_bf16 v[64:79], v[240:243], v[244:247], v[64:79]
    ds_read_b128 v[240:243], v13 offset:192
    ds_read_b64_tr_b16 v[244:245], v15 offset:18432
    ds_read_b64_tr_b16 v[246:247], v15 offset:19200
    s_waitcnt lgkmcnt(9)
    v_mfma_f32_32x32x16_bf16 v[64:79], v[248:251], v[252:255], v[64:79]
    ds_read_b128 v[248:251], v13 offset:224
    ds_read_b64_tr_b16 v[252:253], v15 offset:21504
    ds_read_b64_tr_b16 v[254:255], v15 offset:22272
    s_waitcnt lgkmcnt(9)
    v_mfma_f32_32x32x16_bf16 v[64:79], v[128:131], v[132:135], v[64:79]
    ds_read_b128 v[128:131], v13 offset:256
    ds_read_b64_tr_b16 v[132:133], v15 offset:24576
    ds_read_b64_tr_b16 v[134:135], v15 offset:25344
    s_waitcnt lgkmcnt(9)
    v_mfma_f32_32x32x16_bf16 v[64:79], v[136:139], v[140:143], v[64:79]
    ds_read_b128 v[136:139], v13 offset:288
    ds_read_b64_tr_b16 v[140:141], v15 offset:27648
    ds_read_b64_tr_b16 v[142:143], v15 offset:28416
    s_waitcnt lgkmcnt(9)
    v_mfma_f32_32x32x16_bf16 v[64:79], v[240:243], v[244:247], v[64:79]
    ds_read_b128 v[240:243], v13 offset:320
    ds_read_b64_tr_b16 v[244:245], v15 offset:30720
    ds_read_b64_tr_b16 v[246:247], v15 offset:31488
    s_waitcnt lgkmcnt(9)
    v_mfma_f32_32x32x16_bf16 v[64:79], v[248:251], v[252:255], v[64:79]
    ds_read_b128 v[248:251], v13 offset:352
    ds_read_b64_tr_b16 v[252:253], v15 offset:33792
    ds_read_b64_tr_b16 v[254:255], v15 offset:34560
    s_waitcnt lgkmcnt(9)
    v_mfma_f32_32x32x16_bf16 v[64:79], v[128:131], v[132:135], v[64:79]
    s_waitcnt lgkmcnt(6)
    v_mfma_f32_32x32x16_bf16 v[64:79], v[136:139], v[140:143], v[64:79]
    s_waitcnt lgkmcnt(3)
    v_mfma_f32_32x32x16_bf16 v[64:79], v[240:243], v[244:247], v[64:79]
    s_waitcnt lgkmcnt(0)
    v_mfma_f32_32x32x16_bf16 v[64:79], v[248:251], v[252:255], v[64:79]
    s_barrier
    s_waitcnt vmcnt(12)
    ds_write_b128 v4, v[144:147] offset:0
    ds_write_b128 v4, v[148:151] offset:128
    ds_write_b128 v4, v[152:155] offset:256
    ds_write_b128 v4, v[156:159] offset:12800
    ds_write_b128 v4, v[160:163] offset:12928
    ds_write_b128 v4, v[164:167] offset:13056
    v_add_u32 v18, 25600, v6
    ds_write_b128 v18, v[168:171]
    v_add_u32 v18, 31744, v6
    ds_write_b128 v18, v[172:175]
    v_add_u32 v18, 37888, v6
    ds_write_b128 v18, v[176:179]
    v_add_u32 v18, 44032, v6
    ds_write_b128 v18, v[180:183]
    v_add_u32 v18, 50176, v6
    ds_write_b128 v18, v[184:187]
    v_add_u32 v18, 56320, v6
    ds_write_b128 v18, v[188:191]
    s_waitcnt lgkmcnt(0)
    s_barrier
    v_add_u32 v3, 384, v3
    v_add_u32 v5, 245760, v5
    v_add_u32 v18, 0, v3
    buffer_load_dwordx4 v[144:147], v18, s[20:23], s29 offen
    v_add_u32 v18, 128, v3
    buffer_load_dwordx4 v[148:151], v18, s[20:23], s29 offen
    v_add_u32 v18, 256, v3
    buffer_load_dwordx4 v[152:155], v18, s[20:23], s29 offen
    v_add_u32 v18, 110592, v3
    buffer_load_dwordx4 v[156:159], v18, s[20:23], s29 offen
    v_add_u32 v18, 110720, v3
    buffer_load_dwordx4 v[160:163], v18, s[20:23], s29 offen
    v_add_u32 v18, 110848, v3
    buffer_load_dwordx4 v[164:167], v18, s[20:23], s29 offen
    v_add_u32 v18, 0, v5
    buffer_load_dwordx4 v[168:171], v18, s[12:15], s30 offen
    v_add_u32 v18, 40960, v5
    buffer_load_dwordx4 v[172:175], v18, s[12:15], s30 offen
    v_add_u32 v18, 81920, v5
    buffer_load_dwordx4 v[176:179], v18, s[12:15], s30 offen
    v_add_u32 v18, 122880, v5
    buffer_load_dwordx4 v[180:183], v18, s[12:15], s30 offen
    v_add_u32 v18, 163840, v5
    buffer_load_dwordx4 v[184:187], v18, s[12:15], s30 offen
    v_add_u32 v18, 204800, v5
    buffer_load_dwordx4 v[188:191], v18, s[12:15], s30 offen
    ds_read_b128 v[128:131], v13 offset:0
    ds_read_b64_tr_b16 v[132:133], v15 offset:0
    ds_read_b64_tr_b16 v[134:135], v15 offset:768
    ds_read_b128 v[136:139], v13 offset:32
    ds_read_b64_tr_b16 v[140:141], v15 offset:3072
    ds_read_b64_tr_b16 v[142:143], v15 offset:3840
    ds_read_b128 v[240:243], v13 offset:64
    ds_read_b64_tr_b16 v[244:245], v15 offset:6144
    ds_read_b64_tr_b16 v[246:247], v15 offset:6912
    ds_read_b128 v[248:251], v13 offset:96
    ds_read_b64_tr_b16 v[252:253], v15 offset:9216
    ds_read_b64_tr_b16 v[254:255], v15 offset:9984
    s_waitcnt lgkmcnt(9)
    v_mfma_f32_32x32x16_bf16 v[64:79], v[128:131], v[132:135], v[64:79]
    ds_read_b128 v[128:131], v13 offset:128
    ds_read_b64_tr_b16 v[132:133], v15 offset:12288
    ds_read_b64_tr_b16 v[134:135], v15 offset:13056
    s_waitcnt lgkmcnt(9)
    v_mfma_f32_32x32x16_bf16 v[64:79], v[136:139], v[140:143], v[64:79]
    ds_read_b128 v[136:139], v13 offset:160
    ds_read_b64_tr_b16 v[140:141], v15 offset:15360
    ds_read_b64_tr_b16 v[142:143], v15 offset:16128
    s_waitcnt lgkmcnt(9)
    v_mfma_f32_32x32x16_bf16 v[64:79], v[240:243], v[244:247], v[64:79]
    ds_read_b128 v[240:243], v13 offset:192
    ds_read_b64_tr_b16 v[244:245], v15 offset:18432
    ds_read_b64_tr_b16 v[246:247], v15 offset:19200
    s_waitcnt lgkmcnt(9)
    v_mfma_f32_32x32x16_bf16 v[64:79], v[248:251], v[252:255], v[64:79]
    ds_read_b128 v[248:251], v13 offset:224
    ds_read_b64_tr_b16 v[252:253], v15 offset:21504
    ds_read_b64_tr_b16 v[254:255], v15 offset:22272
    s_waitcnt lgkmcnt(9)
    v_mfma_f32_32x32x16_bf16 v[64:79], v[128:131], v[132:135], v[64:79]
    ds_read_b128 v[128:131], v13 offset:256
    ds_read_b64_tr_b16 v[132:133], v15 offset:24576
    ds_read_b64_tr_b16 v[134:135], v15 offset:25344
    s_waitcnt lgkmcnt(9)
    v_mfma_f32_32x32x16_bf16 v[64:79], v[136:139], v[140:143], v[64:79]
    ds_read_b128 v[136:139], v13 offset:288
    ds_read_b64_tr_b16 v[140:141], v15 offset:27648
    ds_read_b64_tr_b16 v[142:143], v15 offset:28416
    s_waitcnt lgkmcnt(9)
    v_mfma_f32_32x32x16_bf16 v[64:79], v[240:243], v[244:247], v[64:79]
    ds_read_b128 v[240:243], v13 offset:320
    ds_read_b64_tr_b16 v[244:245], v15 offset:30720
    ds_read_b64_tr_b16 v[246:247], v15 offset:31488
    s_waitcnt lgkmcnt(9)
    v_mfma_f32_32x32x16_bf16 v[64:79], v[248:251], v[252:255], v[64:79]
    ds_read_b128 v[248:251], v13 offset:352
    ds_read_b64_tr_b16 v[252:253], v15 offset:33792
    ds_read_b64_tr_b16 v[254:255], v15 offset:34560
    s_waitcnt lgkmcnt(9)
    v_mfma_f32_32x32x16_bf16 v[64:79], v[128:131], v[132:135], v[64:79]
    s_waitcnt lgkmcnt(6)
    v_mfma_f32_32x32x16_bf16 v[64:79], v[136:139], v[140:143], v[64:79]
    s_waitcnt lgkmcnt(3)
    v_mfma_f32_32x32x16_bf16 v[64:79], v[240:243], v[244:247], v[64:79]
    s_waitcnt lgkmcnt(0)
    v_mfma_f32_32x32x16_bf16 v[64:79], v[248:251], v[252:255], v[64:79]
    s_barrier
    s_waitcnt vmcnt(12)
    ds_write_b128 v4, v[192:195] offset:0
    ds_write_b128 v4, v[196:199] offset:128
    ds_write_b128 v4, v[200:203] offset:256
    ds_write_b128 v4, v[204:207] offset:12800
    ds_write_b128 v4, v[208:211] offset:12928
    ds_write_b128 v4, v[212:215] offset:13056
    v_add_u32 v18, 25600, v6
    ds_write_b128 v18, v[216:219]
    v_add_u32 v18, 31744, v6
    ds_write_b128 v18, v[220:223]
    v_add_u32 v18, 37888, v6
    ds_write_b128 v18, v[224:227]
    v_add_u32 v18, 44032, v6
    ds_write_b128 v18, v[228:231]
    v_add_u32 v18, 50176, v6
    ds_write_b128 v18, v[232:235]
    v_add_u32 v18, 56320, v6
    ds_write_b128 v18, v[236:239]
    s_waitcnt lgkmcnt(0)
    s_barrier
    ds_read_b128 v[128:131], v13 offset:0
    ds_read_b64_tr_b16 v[132:133], v15 offset:0
    ds_read_b64_tr_b16 v[134:135], v15 offset:768
    ds_read_b128 v[136:139], v13 offset:32
    ds_read_b64_tr_b16 v[140:141], v15 offset:3072
    ds_read_b64_tr_b16 v[142:143], v15 offset:3840
    ds_read_b128 v[240:243], v13 offset:64
    ds_read_b64_tr_b16 v[244:245], v15 offset:6144
    ds_read_b64_tr_b16 v[246:247], v15 offset:6912
    ds_read_b128 v[248:251], v13 offset:96
    ds_read_b64_tr_b16 v[252:253], v15 offset:9216
    ds_read_b64_tr_b16 v[254:255], v15 offset:9984
    s_waitcnt lgkmcnt(9)
    v_mfma_f32_32x32x16_bf16 v[64:79], v[128:131], v[132:135], v[64:79]
    ds_read_b128 v[128:131], v13 offset:128
    ds_read_b64_tr_b16 v[132:133], v15 offset:12288
    ds_read_b64_tr_b16 v[134:135], v15 offset:13056
    s_waitcnt lgkmcnt(9)
    v_mfma_f32_32x32x16_bf16 v[64:79], v[136:139], v[140:143], v[64:79]
    ds_read_b128 v[136:139], v13 offset:160
    ds_read_b64_tr_b16 v[140:141], v15 offset:15360
    ds_read_b64_tr_b16 v[142:143], v15 offset:16128
    s_waitcnt lgkmcnt(9)
    v_mfma_f32_32x32x16_bf16 v[64:79], v[240:243], v[244:247], v[64:79]
    ds_read_b128 v[240:243], v13 offset:192
    ds_read_b64_tr_b16 v[244:245], v15 offset:18432
    ds_read_b64_tr_b16 v[246:247], v15 offset:19200
    s_waitcnt lgkmcnt(9)
    v_mfma_f32_32x32x16_bf16 v[64:79], v[248:251], v[252:255], v[64:79]
    ds_read_b128 v[248:251], v13 offset:224
    ds_read_b64_tr_b16 v[252:253], v15 offset:21504
    ds_read_b64_tr_b16 v[254:255], v15 offset:22272
    s_waitcnt lgkmcnt(9)
    v_mfma_f32_32x32x16_bf16 v[64:79], v[128:131], v[132:135], v[64:79]
    ds_read_b128 v[128:131], v13 offset:256
    ds_read_b64_tr_b16 v[132:133], v15 offset:24576
    ds_read_b64_tr_b16 v[134:135], v15 offset:25344
    s_waitcnt lgkmcnt(9)
    v_mfma_f32_32x32x16_bf16 v[64:79], v[136:139], v[140:143], v[64:79]
    ds_read_b128 v[136:139], v13 offset:288
    ds_read_b64_tr_b16 v[140:141], v15 offset:27648
    ds_read_b64_tr_b16 v[142:143], v15 offset:28416
    s_waitcnt lgkmcnt(9)
    v_mfma_f32_32x32x16_bf16 v[64:79], v[240:243], v[244:247], v[64:79]
    ds_read_b128 v[240:243], v13 offset:320
    ds_read_b64_tr_b16 v[244:245], v15 offset:30720
    ds_read_b64_tr_b16 v[246:247], v15 offset:31488
    s_waitcnt lgkmcnt(9)
    v_mfma_f32_32x32x16_bf16 v[64:79], v[248:251], v[252:255], v[64:79]
    ds_read_b128 v[248:251], v13 offset:352
    ds_read_b64_tr_b16 v[252:253], v15 offset:33792
    ds_read_b64_tr_b16 v[254:255], v15 offset:34560
    s_waitcnt lgkmcnt(9)
    v_mfma_f32_32x32x16_bf16 v[64:79], v[128:131], v[132:135], v[64:79]
    s_waitcnt lgkmcnt(6)
    v_mfma_f32_32x32x16_bf16 v[64:79], v[136:139], v[140:143], v[64:79]
    s_waitcnt lgkmcnt(3)
    v_mfma_f32_32x32x16_bf16 v[64:79], v[240:243], v[244:247], v[64:79]
    s_waitcnt lgkmcnt(0)
    v_mfma_f32_32x32x16_bf16 v[64:79], v[248:251], v[252:255], v[64:79]
    s_barrier
    s_waitcnt vmcnt(0)
    ds_write_b128 v4, v[144:147] offset:0
    ds_write_b128 v4, v[148:151] offset:128
    ds_write_b128 v4, v[152:155] offset:256
    ds_write_b128 v4, v[156:159] offset:12800
    ds_write_b128 v4, v[160:163] offset:12928
    ds_write_b128 v4, v[164:167] offset:13056
    v_add_u32 v18, 25600, v6
    ds_write_b128 v18, v[168:171]
    v_add_u32 v18, 31744, v6
    ds_write_b128 v18, v[172:175]
    v_add_u32 v18, 37888, v6
    ds_write_b128 v18, v[176:179]
    v_add_u32 v18, 44032, v6
    ds_write_b128 v18, v[180:183]
    v_add_u32 v18, 50176, v6
    ds_write_b128 v18, v[184:187]
    v_add_u32 v18, 56320, v6
    ds_write_b128 v18, v[188:191]
    s_waitcnt lgkmcnt(0)
    s_barrier
    ds_read_b128 v[128:131], v13 offset:0
    ds_read_b64_tr_b16 v[132:133], v15 offset:0
    ds_read_b64_tr_b16 v[134:135], v15 offset:768
    ds_read_b128 v[136:139], v13 offset:32
    ds_read_b64_tr_b16 v[140:141], v15 offset:3072
    ds_read_b64_tr_b16 v[142:143], v15 offset:3840
    ds_read_b128 v[240:243], v13 offset:64
    ds_read_b64_tr_b16 v[244:245], v15 offset:6144
    ds_read_b64_tr_b16 v[246:247], v15 offset:6912
    ds_read_b128 v[248:251], v13 offset:96
    ds_read_b64_tr_b16 v[252:253], v15 offset:9216
    ds_read_b64_tr_b16 v[254:255], v15 offset:9984
    s_waitcnt lgkmcnt(9)
    v_mfma_f32_32x32x16_bf16 v[64:79], v[128:131], v[132:135], v[64:79]
    ds_read_b128 v[128:131], v13 offset:128
    ds_read_b64_tr_b16 v[132:133], v15 offset:12288
    ds_read_b64_tr_b16 v[134:135], v15 offset:13056
    s_waitcnt lgkmcnt(9)
    v_mfma_f32_32x32x16_bf16 v[64:79], v[136:139], v[140:143], v[64:79]
    ds_read_b128 v[136:139], v13 offset:160
    ds_read_b64_tr_b16 v[140:141], v15 offset:15360
    ds_read_b64_tr_b16 v[142:143], v15 offset:16128
    s_waitcnt lgkmcnt(9)
    v_mfma_f32_32x32x16_bf16 v[64:79], v[240:243], v[244:247], v[64:79]
    ds_read_b128 v[240:243], v13 offset:192
    ds_read_b64_tr_b16 v[244:245], v15 offset:18432
    ds_read_b64_tr_b16 v[246:247], v15 offset:19200
    s_waitcnt lgkmcnt(9)
    v_mfma_f32_32x32x16_bf16 v[64:79], v[248:251], v[252:255], v[64:79]
    ds_read_b128 v[248:251], v13 offset:224
    ds_read_b64_tr_b16 v[252:253], v15 offset:21504
    ds_read_b64_tr_b16 v[254:255], v15 offset:22272
    s_waitcnt lgkmcnt(9)
    v_mfma_f32_32x32x16_bf16 v[64:79], v[128:131], v[132:135], v[64:79]
    ds_read_b128 v[128:131], v13 offset:256
    ds_read_b64_tr_b16 v[132:133], v15 offset:24576
    ds_read_b64_tr_b16 v[134:135], v15 offset:25344
    s_waitcnt lgkmcnt(9)
    v_mfma_f32_32x32x16_bf16 v[64:79], v[136:139], v[140:143], v[64:79]
    ds_read_b128 v[136:139], v13 offset:288
    ds_read_b64_tr_b16 v[140:141], v15 offset:27648
    ds_read_b64_tr_b16 v[142:143], v15 offset:28416
    s_waitcnt lgkmcnt(9)
    v_mfma_f32_32x32x16_bf16 v[64:79], v[240:243], v[244:247], v[64:79]
    ds_read_b128 v[240:243], v13 offset:320
    ds_read_b64_tr_b16 v[244:245], v15 offset:30720
    ds_read_b64_tr_b16 v[246:247], v15 offset:31488
    s_waitcnt lgkmcnt(9)
    v_mfma_f32_32x32x16_bf16 v[64:79], v[248:251], v[252:255], v[64:79]
    ds_read_b128 v[248:251], v13 offset:352
    ds_read_b64_tr_b16 v[252:253], v15 offset:33792
    ds_read_b64_tr_b16 v[254:255], v15 offset:34560
    s_waitcnt lgkmcnt(9)
    v_mfma_f32_32x32x16_bf16 v[64:79], v[128:131], v[132:135], v[64:79]
    s_waitcnt lgkmcnt(6)
    v_mfma_f32_32x32x16_bf16 v[64:79], v[136:139], v[140:143], v[64:79]
    s_waitcnt lgkmcnt(3)
    v_mfma_f32_32x32x16_bf16 v[64:79], v[240:243], v[244:247], v[64:79]
    s_waitcnt lgkmcnt(0)
    v_mfma_f32_32x32x16_bf16 v[64:79], v[248:251], v[252:255], v[64:79]
    s_barrier
    s_nop 15
    v_mul_u32_u24 v20, 32, v9
    v_add_u32 v20, s27, v20
    v_lshl_add_u32 v20, v12, 2, v20
    v_lshl_add_u32 v21, v10, 5, v11
    s_movk_i32 s28, 1280
    v_mul_lo_u32 v22, v20, s28
    v_lshl_add_u32 v22, v21, 1, v22
    v_add_u32 v22, s30, v22
    s_mov_b32 s33, 9437184
    s_lshl_b32 s35, s30, 1
    s_add_u32 s35, s35, 12800
    v_lshlrev_b32 v25, 2, v21
    buffer_load_dword v26, v25, s[20:23], s35 offen offset:0
    v_add_u32 v28, 0, v22
    buffer_load_ushort v44, v28, s[20:23], s33 offen
    v_add_u32 v29, 1280, v22
    buffer_load_ushort v45, v29, s[20:23], s33 offen
    v_add_u32 v30, 2560, v22
    buffer_load_ushort v46, v30, s[20:23], s33 offen
    v_add_u32 v31, 3840, v22
    buffer_load_ushort v47, v31, s[20:23], s33 offen
    v_add_u32 v32, 10240, v22
    buffer_load_ushort v48, v32, s[20:23], s33 offen
    v_add_u32 v33, 11520, v22
    buffer_load_ushort v49, v33, s[20:23], s33 offen
    v_add_u32 v34, 12800, v22
    buffer_load_ushort v50, v34, s[20:23], s33 offen
    v_add_u32 v35, 14080, v22
    buffer_load_ushort v51, v35, s[20:23], s33 offen
    v_add_u32 v36, 20480, v22
    buffer_load_ushort v52, v36, s[20:23], s33 offen
    v_add_u32 v37, 21760, v22
    buffer_load_ushort v53, v37, s[20:23], s33 offen
    v_add_u32 v38, 23040, v22
    buffer_load_ushort v54, v38, s[20:23], s33 offen
    v_add_u32 v39, 24320, v22
    buffer_load_ushort v55, v39, s[20:23], s33 offen
    v_add_u32 v40, 30720, v22
    buffer_load_ushort v56, v40, s[20:23], s33 offen
    v_add_u32 v41, 32000, v22
    buffer_load_ushort v57, v41, s[20:23], s33 offen
    v_add_u32 v42, 33280, v22
    buffer_load_ushort v58, v42, s[20:23], s33 offen
    v_add_u32 v43, 34560, v22
    buffer_load_ushort v59, v43, s[20:23], s33 offen
    s_waitcnt vmcnt(0)
    v_cvt_pk_bf16_f32 v64, v64, v64
    v_lshlrev_b32 v64, 16, v64
    v_mul_f32 v64, v64, v26
    v_cvt_pk_bf16_f32 v64, v64, v64
    v_lshlrev_b32 v64, 16, v64
    v_lshlrev_b32 v27, 16, v44
    v_add_f32 v64, v64, v27
    v_cvt_pk_bf16_f32 v64, v64, v64
    buffer_store_short v64, v28, s[40:43], 0 offen
    v_cvt_pk_bf16_f32 v65, v65, v65
    v_lshlrev_b32 v65, 16, v65
    v_mul_f32 v65, v65, v26
    v_cvt_pk_bf16_f32 v65, v65, v65
    v_lshlrev_b32 v65, 16, v65
    v_lshlrev_b32 v27, 16, v45
    v_add_f32 v65, v65, v27
    v_cvt_pk_bf16_f32 v65, v65, v65
    buffer_store_short v65, v29, s[40:43], 0 offen
    v_cvt_pk_bf16_f32 v66, v66, v66
    v_lshlrev_b32 v66, 16, v66
    v_mul_f32 v66, v66, v26
    v_cvt_pk_bf16_f32 v66, v66, v66
    v_lshlrev_b32 v66, 16, v66
    v_lshlrev_b32 v27, 16, v46
    v_add_f32 v66, v66, v27
    v_cvt_pk_bf16_f32 v66, v66, v66
    buffer_store_short v66, v30, s[40:43], 0 offen
    v_cvt_pk_bf16_f32 v67, v67, v67
    v_lshlrev_b32 v67, 16, v67
    v_mul_f32 v67, v67, v26
    v_cvt_pk_bf16_f32 v67, v67, v67
    v_lshlrev_b32 v67, 16, v67
    v_lshlrev_b32 v27, 16, v47
    v_add_f32 v67, v67, v27
    v_cvt_pk_bf16_f32 v67, v67, v67
    buffer_store_short v67, v31, s[40:43], 0 offen
    v_cvt_pk_bf16_f32 v68, v68, v68
    v_lshlrev_b32 v68, 16, v68
    v_mul_f32 v68, v68, v26
    v_cvt_pk_bf16_f32 v68, v68, v68
    v_lshlrev_b32 v68, 16, v68
    v_lshlrev_b32 v27, 16, v48
    v_add_f32 v68, v68, v27
    v_cvt_pk_bf16_f32 v68, v68, v68
    buffer_store_short v68, v32, s[40:43], 0 offen
    v_cvt_pk_bf16_f32 v69, v69, v69
    v_lshlrev_b32 v69, 16, v69
    v_mul_f32 v69, v69, v26
    v_cvt_pk_bf16_f32 v69, v69, v69
    v_lshlrev_b32 v69, 16, v69
    v_lshlrev_b32 v27, 16, v49
    v_add_f32 v69, v69, v27
    v_cvt_pk_bf16_f32 v69, v69, v69
    buffer_store_short v69, v33, s[40:43], 0 offen
    v_cvt_pk_bf16_f32 v70, v70, v70
    v_lshlrev_b32 v70, 16, v70
    v_mul_f32 v70, v70, v26
    v_cvt_pk_bf16_f32 v70, v70, v70
    v_lshlrev_b32 v70, 16, v70
    v_lshlrev_b32 v27, 16, v50
    v_add_f32 v70, v70, v27
    v_cvt_pk_bf16_f32 v70, v70, v70
    buffer_store_short v70, v34, s[40:43], 0 offen
    v_cvt_pk_bf16_f32 v71, v71, v71
    v_lshlrev_b32 v71, 16, v71
    v_mul_f32 v71, v71, v26
    v_cvt_pk_bf16_f32 v71, v71, v71
    v_lshlrev_b32 v71, 16, v71
    v_lshlrev_b32 v27, 16, v51
    v_add_f32 v71, v71, v27
    v_cvt_pk_bf16_f32 v71, v71, v71
    buffer_store_short v71, v35, s[40:43], 0 offen
    v_cvt_pk_bf16_f32 v72, v72, v72
    v_lshlrev_b32 v72, 16, v72
    v_mul_f32 v72, v72, v26
    v_cvt_pk_bf16_f32 v72, v72, v72
    v_lshlrev_b32 v72, 16, v72
    v_lshlrev_b32 v27, 16, v52
    v_add_f32 v72, v72, v27
    v_cvt_pk_bf16_f32 v72, v72, v72
    buffer_store_short v72, v36, s[40:43], 0 offen
    v_cvt_pk_bf16_f32 v73, v73, v73
    v_lshlrev_b32 v73, 16, v73
    v_mul_f32 v73, v73, v26
    v_cvt_pk_bf16_f32 v73, v73, v73
    v_lshlrev_b32 v73, 16, v73
    v_lshlrev_b32 v27, 16, v53
    v_add_f32 v73, v73, v27
    v_cvt_pk_bf16_f32 v73, v73, v73
    buffer_store_short v73, v37, s[40:43], 0 offen
    v_cvt_pk_bf16_f32 v74, v74, v74
    v_lshlrev_b32 v74, 16, v74
    v_mul_f32 v74, v74, v26
    v_cvt_pk_bf16_f32 v74, v74, v74
    v_lshlrev_b32 v74, 16, v74
    v_lshlrev_b32 v27, 16, v54
    v_add_f32 v74, v74, v27
    v_cvt_pk_bf16_f32 v74, v74, v74
    buffer_store_short v74, v38, s[40:43], 0 offen
    v_cvt_pk_bf16_f32 v75, v75, v75
    v_lshlrev_b32 v75, 16, v75
    v_mul_f32 v75, v75, v26
    v_cvt_pk_bf16_f32 v75, v75, v75
    v_lshlrev_b32 v75, 16, v75
    v_lshlrev_b32 v27, 16, v55
    v_add_f32 v75, v75, v27
    v_cvt_pk_bf16_f32 v75, v75, v75
    buffer_store_short v75, v39, s[40:43], 0 offen
    v_cvt_pk_bf16_f32 v76, v76, v76
    v_lshlrev_b32 v76, 16, v76
    v_mul_f32 v76, v76, v26
    v_cvt_pk_bf16_f32 v76, v76, v76
    v_lshlrev_b32 v76, 16, v76
    v_lshlrev_b32 v27, 16, v56
    v_add_f32 v76, v76, v27
    v_cvt_pk_bf16_f32 v76, v76, v76
    buffer_store_short v76, v40, s[40:43], 0 offen
    v_cvt_pk_bf16_f32 v77, v77, v77
    v_lshlrev_b32 v77, 16, v77
    v_mul_f32 v77, v77, v26
    v_cvt_pk_bf16_f32 v77, v77, v77
    v_lshlrev_b32 v77, 16, v77
    v_lshlrev_b32 v27, 16, v57
    v_add_f32 v77, v77, v27
    v_cvt_pk_bf16_f32 v77, v77, v77
    buffer_store_short v77, v41, s[40:43], 0 offen
    v_cvt_pk_bf16_f32 v78, v78, v78
    v_lshlrev_b32 v78, 16, v78
    v_mul_f32 v78, v78, v26
    v_cvt_pk_bf16_f32 v78, v78, v78
    v_lshlrev_b32 v78, 16, v78
    v_lshlrev_b32 v27, 16, v58
    v_add_f32 v78, v78, v27
    v_cvt_pk_bf16_f32 v78, v78, v78
    buffer_store_short v78, v42, s[40:43], 0 offen
    v_cvt_pk_bf16_f32 v79, v79, v79
    v_lshlrev_b32 v79, 16, v79
    v_mul_f32 v79, v79, v26
    v_cvt_pk_bf16_f32 v79, v79, v79
    v_lshlrev_b32 v79, 16, v79
    v_lshlrev_b32 v27, 16, v59
    v_add_f32 v79, v79, v27
    v_cvt_pk_bf16_f32 v79, v79, v79
    buffer_store_short v79, v43, s[40:43], 0 offen
    s_endpgm
.section .rodata,"a"
.p2align 6
.amdhsa_kernel k0_kernel
  .amdhsa_next_free_vgpr 128
  .amdhsa_next_free_sgpr 64
  .amdhsa_accum_offset 128
  .amdhsa_group_segment_fixed_size 0
  .amdhsa_kernarg_size 144
  .amdhsa_user_sgpr_count 2
  .amdhsa_user_sgpr_kernarg_segment_ptr 1
  .amdhsa_system_sgpr_workgroup_id_x 1
.end_amdhsa_kernel
.p2align 6
.amdhsa_kernel k2_kernel
  .amdhsa_next_free_vgpr 96
  .amdhsa_next_free_sgpr 64
  .amdhsa_accum_offset 96
  .amdhsa_group_segment_fixed_size 0
  .amdhsa_kernarg_size 144
  .amdhsa_user_sgpr_count 2
  .amdhsa_user_sgpr_kernarg_segment_ptr 1
  .amdhsa_system_sgpr_workgroup_id_x 1
.end_amdhsa_kernel
.p2align 6
.amdhsa_kernel k3_kernel
  .amdhsa_next_free_vgpr 168
  .amdhsa_next_free_sgpr 64
  .amdhsa_accum_offset 168
  .amdhsa_group_segment_fixed_size 0
  .amdhsa_kernarg_size 144
  .amdhsa_user_sgpr_count 2
  .amdhsa_user_sgpr_kernarg_segment_ptr 1
  .amdhsa_system_sgpr_workgroup_id_x 1
.end_amdhsa_kernel
.p2align 6
.amdhsa_kernel k4_kernel
  .amdhsa_next_free_vgpr 256
  .amdhsa_next_free_sgpr 64
  .amdhsa_accum_offset 256
  .amdhsa_group_segment_fixed_size 0
  .amdhsa_kernarg_size 144
  .amdhsa_user_sgpr_count 2
  .amdhsa_user_sgpr_kernarg_segment_ptr 1
  .amdhsa_system_sgpr_workgroup_id_x 1
.end_amdhsa_kernel
.p2align 6
.amdhsa_kernel k5_kernel
  .amdhsa_next_free_vgpr 256
  .amdhsa_next_free_sgpr 64
  .amdhsa_accum_offset 256
  .amdhsa_group_segment_fixed_size 0
  .amdhsa_kernarg_size 144
  .amdhsa_user_sgpr_count 2
  .amdhsa_user_sgpr_kernarg_segment_ptr 1
  .amdhsa_system_sgpr_workgroup_id_x 1
.end_amdhsa_kernel
```
